```python
import torch

def _softmax(x, axis=-1):
    return torch.softmax(x, dim=axis)
def _gelu(x):
    return torch.nn.functional.gelu(x, approximate="tanh")
def _silu(x):
    return torch.nn.functional.silu(x)
def _sigmoid(x):
    return torch.sigmoid(x)
def _layernorm(x, axis=-1, eps=1e-5):
    m = x.mean(dim=axis, keepdim=True)
    v = x.var(dim=axis, keepdim=True, unbiased=False)
    return (x - m) / torch.sqrt(v + eps)
def _scatter_add(tgt, idx, src, axis=0):
    return tgt.clone().index_add_(axis, idx, src)
def _segment_sum(src, seg, n):
    out = torch.zeros((n,) + src.shape[1:], dtype=src.dtype)
    return out.index_add_(0, seg, src)
def _pad(x, pw):
    flat = tuple(v for pair in reversed(pw) for v in pair)
    return torch.nn.functional.pad(x, flat)

kernel_name = 'parallel_sum__spectral_gfnet__mixer_token_mlp__prompt'

def setup_inputs():

    _w = (lambda a: (lambda t: t.to(torch.bfloat16) if t.is_floating_point() else t)(torch.as_tensor(a)))
    def _A_setup():
        B, S, D = 1, 2048, 512
        Df = D // 2 + 1
        return {
            "x": _w((lambda *s: torch.randn(*s, dtype=torch.bfloat16) * 0.05)(B, S, D)),
            "w_r": _w((lambda *s: torch.randn(*s, dtype=torch.bfloat16) * 0.2)(S, Df) * 0.02),
            "w_i": _w((lambda *s: torch.randn(*s, dtype=torch.bfloat16) * 0.2)(S, Df) * 0.02),
        }
    _A_in = _A_setup()

    def _B_setup():
        B, S, D, F = 1, 2048, 512, 1792
        return {
            "x": _w((lambda *s: torch.randn(*s, dtype=torch.bfloat16) * 0.05)(B, S, D)),
            "w1": _w((lambda *s: torch.randn(*s, dtype=torch.bfloat16) * 0.4)(S, F) * (S ** -0.5)),
            "b1": _w((lambda *s: torch.randn(*s, dtype=torch.bfloat16) * 3.2)(F) * 0.02),
            "w2": _w((lambda *s: torch.randn(*s, dtype=torch.bfloat16) * 0.1)(F, S) * (F ** -0.5)),
            "b2": _w((lambda *s: torch.randn(*s, dtype=torch.bfloat16) * 0.4)(S) * 0.02),
        }
    _B_in = _B_setup()

    return {
        "A_x": _A_in["x"],
        "A_w_r": _A_in["w_r"],
        "A_w_i": _A_in["w_i"],
        "B_x": _B_in["x"],
        "B_w1": _B_in["w1"],
        "B_b1": _B_in["b1"],
        "B_w2": _B_in["w2"],
        "B_b2": _B_in["b2"],
    }

def reference(A_x, A_w_r, A_w_i, B_x, B_w1, B_b1, B_w2, B_b2):
    def _A_ref(x, w_r, w_i):
        B, S, D = x.shape
        X = (lambda x, axes=(-2,-1): torch.fft.rfft2(x.float(), dim=axes))(x, axes=(-2, -1))
        W = w_r + 1j * w_i
        X = X * W
        y = (lambda x, s, axes=(-2,-1): torch.fft.irfft2(x, s=s, dim=axes).to(torch.bfloat16))(X, (S, D), axes=(-2, -1))
        return y

    def _B_ref(x, w1, b1, w2, b2):
        B, S, D = x.shape
        h = _layernorm(x, axis=-1)
        u = torch.einsum("bsd,sf->bdf", h, w1) + b1
        u = _gelu(u)
        y = torch.einsum("bdf,fs->bds", u, w2) + b2
        return (lambda x, *d: x.permute(*d))(y, 0, 2, 1)

    x = A_x
    xn = _layernorm(x, axis=-1)
    return x + _A_ref(xn, A_w_r, A_w_i) + _B_ref(xn, B_w1, B_b1, B_w2, B_b2)
```

```asm
; @launch grid=(256,1,1) block=(256,1,1) lds=163840
.amdgcn_target "amdgcn-amd-amdhsa--gfx950"
.text
.globl parallel_sum__spectral_gfnet__mixer_token_mlp__prompt_kernel
.p2align 8
.type parallel_sum__spectral_gfnet__mixer_token_mlp__prompt_kernel,@function
parallel_sum__spectral_gfnet__mixer_token_mlp__prompt_kernel:
fz_start:
  s_load_dwordx16 s[4:19], s[0:1], 0
  s_load_dwordx2 s[20:21], s[0:1], 80
  s_load_dwordx2 s[22:23], s[0:1], 64
  s_load_dwordx2 s[62:63], s[0:1], 72
  s_cmp_ge_u32 s2, 256
  s_cbranch_scc1 fz_done
  v_lshrrev_b32 v2, 6, v0
  v_and_b32 v1, 63, v0
  v_readfirstlane_b32 s3, v2
  s_and_b32 s64, s2, 7
  s_lshr_b32 s65, s2, 3
  s_lshl_b32 s44, s64, 5
  s_add_u32 s44, s44, s65
  s_lshl_b32 s45, s44, 3
  s_lshl_b32 s46, s3, 1
  s_add_u32 s46, s46, s45
  s_lshl_b32 s46, s46, 10
  v_lshlrev_b32 v3, 4, v1
  s_and_b32 s47, s65, 3
  s_lshr_b32 s48, s65, 2
  s_lshl_b32 s48, s48, 3
  s_add_u32 s48, s48, s64
  s_and_b32 s49, s48, 1
  s_bfe_u32 s50, s48, 0x10001
  s_bfe_u32 s51, s48, 0x20002
  s_lshr_b32 s52, s48, 4
  s_lshl_b32 s52, s52, 3
  s_lshl_b32 s53, s49, 5
  s_add_u32 s53, s53, s52
  s_lshl_b32 s54, s3, 1
  s_add_u32 s53, s53, s54
  s_lshl_b32 s54, s50, 10
  s_add_u32 s53, s53, s54
  s_lshl_b32 s54, s51, 8
  s_add_u32 s53, s53, s54
  s_mul_i32 s53, s53, 514
  s_lshl_b32 s54, s47, 6
  v_add_u32 v4, s54, v1
  v_mov_b32 v5, 0x100
  v_cmp_eq_u32 vcc, 0, v4
  s_nop 1
  v_cndmask_b32 v188, v4, v5, vcc
  v_lshlrev_b32 v188, 1, v188
  s_waitcnt lgkmcnt(0)
  s_mov_b32 s24, s4
  s_and_b32 s25, s5, 0xffff
  s_mov_b32 s26, 2097152
  s_mov_b32 s27, 0x20000
  buffer_load_dwordx4 v[8:11], v3, s[24:27], s46 offen
  buffer_load_dwordx4 v[12:15], v3, s[24:27], s46 offen offset:1024
  s_mov_b32 s32, s6
  s_and_b32 s33, s7, 0xffff
  s_mov_b32 s34, 1052672
  s_mov_b32 s35, 0x20000
  s_mov_b32 s36, s8
  s_and_b32 s37, s9, 0xffff
  s_mov_b32 s38, 1052672
  s_mov_b32 s39, 0x20000
  buffer_load_ushort v172, v188, s[32:35], s53 offen offset:0
  buffer_load_ushort v173, v188, s[36:39], s53 offen offset:0
  buffer_load_ushort v180, v188, s[32:35], s53 offen offset:514
  buffer_load_ushort v181, v188, s[36:39], s53 offen offset:514
  s_add_u32 s53, s53, 32896
  buffer_load_ushort v174, v188, s[32:35], s53 offen offset:0
  buffer_load_ushort v175, v188, s[36:39], s53 offen offset:0
  buffer_load_ushort v182, v188, s[32:35], s53 offen offset:514
  buffer_load_ushort v183, v188, s[36:39], s53 offen offset:514
  s_add_u32 s53, s53, 32896
  buffer_load_ushort v176, v188, s[32:35], s53 offen offset:0
  buffer_load_ushort v177, v188, s[36:39], s53 offen offset:0
  buffer_load_ushort v184, v188, s[32:35], s53 offen offset:514
  buffer_load_ushort v185, v188, s[36:39], s53 offen offset:514
  s_add_u32 s53, s53, 32896
  buffer_load_ushort v178, v188, s[32:35], s53 offen offset:0
  buffer_load_ushort v179, v188, s[36:39], s53 offen offset:0
  buffer_load_ushort v186, v188, s[32:35], s53 offen offset:514
  buffer_load_ushort v187, v188, s[36:39], s53 offen offset:514
  s_mov_b32 s28, s20
  s_and_b32 s29, s21, 0xffff
  s_mov_b32 s30, 268435456
  s_mov_b32 s31, 0x20000
  s_getpc_b64 s[40:41]
fz_pc:
  s_sub_u32 s40, s40, fz_pc-fz_start
  s_subb_u32 s41, s41, 0
  s_lshl_b32 s72, s65, 11
  s_lshl_b32 s73, s3, 9
  s_add_u32 s72, s72, s73
  v_and_b32 v190, 7, v1
  v_lshlrev_b32 v190, 6, v190
  v_add_u32 v190, s72, v190
  v_min_u32 v190, fz_codeend-fz_start-4, v190
  s_mov_b64 exec, 0xff
  global_load_dword v191, v190, s[40:41]
  s_mov_b64 exec, -1
  s_cmp_lg_u32 s2, 0
  s_cbranch_scc1 fz_noinit
  s_cmp_lg_u32 s3, 3
  s_cbranch_scc1 fz_noinit
  v_lshlrev_b32 v190, 7, v1
  v_mov_b32 v191, 0
  s_mov_b32 s72, 12582912
  buffer_store_dword v191, v190, s[28:31], s72 offen sc1
  s_add_u32 s72, s72, 8192
  buffer_store_dword v191, v190, s[28:31], s72 offen sc1
  s_waitcnt vmcnt(0)
  s_mov_b32 s40, s62
  s_and_b32 s41, s63, 0xffff
  s_mov_b32 s42, 256
  s_mov_b32 s43, 0x20000
  v_mov_b32 v190, 0
  v_mov_b32 v191, 1
  s_mov_b64 exec, 1
  buffer_store_dword v191, v190, s[40:43], 0 offen sc1
  s_mov_b64 exec, -1
fz_noinit:
  s_mov_b32 s40, s12
  s_and_b32 s41, s13, 0xffff
  s_mov_b32 s42, 7340032
  s_mov_b32 s43, 0x20000
  s_lshr_b32 s58, s64, 1
  s_mul_i32 s58, s58, 896
  s_lshl_b32 s59, s65, 2
  s_add_u32 s59, s59, s3
  s_lshl_b32 s59, s59, 4
  s_and_b32 s57, s64, 1
  s_lshl_b32 s57, s57, 3
  s_add_u32 s101, s59, 8
  s_sub_u32 s101, s101, s57
  s_add_u32 s59, s59, s57
  s_mul_i32 s59, s59, 3584
  s_mul_i32 s101, s101, 3584
  s_add_u32 s101, s101, s58
  s_add_u32 s58, s58, s59
  v_cmp_gt_u32 vcc, 56, v1
  v_mov_b32 v190, 0x7fffff00
  s_nop 0
  v_cndmask_b32 v189, v190, v3, vcc
  buffer_load_dwordx4 v[192:195], v189, s[40:43], s58 offen
  s_add_u32 s58, s58, 3584
  buffer_load_dwordx4 v[192:195], v189, s[40:43], s58 offen
  s_add_u32 s58, s58, 3584
  buffer_load_dwordx4 v[192:195], v189, s[40:43], s58 offen
  s_add_u32 s58, s58, 3584
  buffer_load_dwordx4 v[192:195], v189, s[40:43], s58 offen
  s_add_u32 s58, s58, 3584
  buffer_load_dwordx4 v[192:195], v189, s[40:43], s58 offen
  s_add_u32 s58, s58, 3584
  buffer_load_dwordx4 v[192:195], v189, s[40:43], s58 offen
  s_add_u32 s58, s58, 3584
  buffer_load_dwordx4 v[192:195], v189, s[40:43], s58 offen
  s_add_u32 s58, s58, 3584
  buffer_load_dwordx4 v[192:195], v189, s[40:43], s58 offen
  s_add_u32 s58, s58, 3584
  s_and_b32 s55, s3, 1
  s_lshr_b32 s56, s3, 1
  v_and_b32 v4, 15, v1
  v_lshrrev_b32 v5, 4, v1
  s_lshl_b32 s57, s55, 4
  v_add_u32 v6, s57, v4
  v_cvt_f32_u32 v40, v6
  v_mul_f32 v40, 0x3d000000, v40
  v_lshlrev_b32 v41, 2, v5
  v_cvt_f32_u32 v41, v41
  v_mul_f32 v42, v41, v40
  v_mul_f32 v43, 0x41800000, v40
  v_add_f32 v43, v43, v42
  v_mov_b32 v44, v42
  v_add_f32 v45, v44, v40
  v_add_f32 v46, v45, v40
  v_add_f32 v47, v46, v40
  v_mov_b32 v48, v43
  v_add_f32 v49, v48, v40
  v_add_f32 v50, v49, v40
  v_add_f32 v51, v50, v40
  v_cos_f32 v52, v44
  v_cos_f32 v53, v45
  v_cos_f32 v54, v46
  v_cos_f32 v55, v47
  v_cos_f32 v56, v48
  v_cos_f32 v57, v49
  v_cos_f32 v58, v50
  v_cos_f32 v59, v51
  v_sin_f32 v44, v44
  v_sin_f32 v45, v45
  v_sin_f32 v46, v46
  v_sin_f32 v47, v47
  v_sin_f32 v48, v48
  v_sin_f32 v49, v49
  v_sin_f32 v50, v50
  v_sin_f32 v51, v51
  v_cvt_pk_bf16_f32 v16, v52, v53
  v_cvt_pk_bf16_f32 v17, v54, v55
  v_cvt_pk_bf16_f32 v18, v56, v57
  v_cvt_pk_bf16_f32 v19, v58, v59
  v_cvt_pk_bf16_f32 v20, -v44, -v45
  v_cvt_pk_bf16_f32 v21, -v46, -v47
  v_cvt_pk_bf16_f32 v22, -v48, -v49
  v_cvt_pk_bf16_f32 v23, -v50, -v51
  v_lshrrev_b32 v44, 1, v4
  v_cvt_f32_u32 v44, v44
  v_mul_f32 v44, 0x3d800000, v44
  v_mul_f32 v45, v41, v44
  v_add_f32 v46, v45, v44
  v_add_f32 v47, v46, v44
  v_add_f32 v48, v47, v44
  v_and_b32 v49, 1, v4
  v_cmp_eq_u32 vcc, 1, v49
  v_cos_f32 v52, v45
  v_cos_f32 v53, v46
  v_cos_f32 v54, v47
  v_cos_f32 v55, v48
  v_sin_f32 v56, v45
  v_sin_f32 v57, v46
  v_sin_f32 v58, v47
  v_sin_f32 v59, v48
  v_sub_f32 v60, 0, v56
  v_cndmask_b32 v44, v52, v60, vcc
  v_cndmask_b32 v48, v56, v52, vcc
  v_sub_f32 v60, 0, v57
  v_cndmask_b32 v45, v53, v60, vcc
  v_cndmask_b32 v49, v57, v53, vcc
  v_sub_f32 v60, 0, v58
  v_cndmask_b32 v46, v54, v60, vcc
  v_cndmask_b32 v50, v58, v54, vcc
  v_sub_f32 v60, 0, v59
  v_cndmask_b32 v47, v55, v60, vcc
  v_cndmask_b32 v51, v59, v55, vcc
  v_cvt_pk_bf16_f32 v24, v44, v45
  v_cvt_pk_bf16_f32 v25, v46, v47
  v_cvt_pk_bf16_f32 v26, v48, v49
  v_cvt_pk_bf16_f32 v27, v50, v51
  v_cmp_eq_u32 vcc, 0, v6
  v_mov_b32 v44, 0x100
  s_nop 0
  v_cndmask_b32 v44, v6, v44, vcc
  v_cvt_f32_u32 v44, v44
  v_mul_f32 v44, 0x3b000000, v44
  v_mul_f32 v45, v41, v44
  v_add_f32 v46, v45, v44
  v_add_f32 v47, v46, v44
  v_add_f32 v48, v47, v44
  v_cos_f32 v28, v45
  v_cos_f32 v29, v46
  v_cos_f32 v30, v47
  v_cos_f32 v31, v48
  v_sin_f32 v32, v45
  v_sin_f32 v33, v46
  v_sin_f32 v34, v47
  v_sin_f32 v35, v48
  s_mov_b64 s[60:61], vcc
  v_lshlrev_b32 v44, 1, v5
  v_add_u32 v44, 0, v44
  v_lshlrev_b32 v45, 5, v44
  v_add_u32 v46, v6, v45
  v_sub_u32 v47, 0x100, v45
  v_cmp_lt_u32 vcc, 0, v44
  s_nop 2
  s_and_b64 vcc, vcc, s[60:61]
  v_cndmask_b32 v46, v46, v47, vcc
  v_lshlrev_b32 v36, 5, v46
  v_mov_b32 v47, 0x80008000
  v_cndmask_b32 v38, 0, v47, vcc
  v_lshlrev_b32 v44, 1, v5
  v_add_u32 v44, 1, v44
  v_lshlrev_b32 v45, 5, v44
  v_add_u32 v46, v6, v45
  v_sub_u32 v47, 0x100, v45
  v_cmp_lt_u32 vcc, 0, v44
  s_nop 2
  s_and_b64 vcc, vcc, s[60:61]
  v_cndmask_b32 v46, v46, v47, vcc
  v_lshlrev_b32 v37, 5, v46
  v_mov_b32 v47, 0x80008000
  v_cndmask_b32 v39, 0, v47, vcc
  s_lshl_b32 s57, s56, 3
  s_add_u32 s57, s57, 148992
  v_add_u32 v36, s57, v36
  v_add_u32 v37, s57, v37
  s_lshr_b32 s60, s44, 1
  s_lshl_b32 s60, s60, 11
  s_and_b32 s61, s44, 1
  s_lshl_b32 s61, s61, 9
  s_add_u32 s60, s60, s61
  s_lshl_b32 s61, s3, 19
  s_add_u32 s60, s60, s61
  s_add_u32 s60, s60, 0
  s_add_u32 s61, s60, 262144
  s_lshl_b32 s57, s3, 11
  s_add_u32 s57, s57, 122880
  v_add_u32 v2, s57, v3
  s_mul_i32 s57, s3, 2176
  s_add_u32 s57, s57, 131072
  v_add_u32 v7, s57, v3
  v_bfe_u32 v44, v1, 2, 2
  v_mul_u32_u24 v40, 1088, v44
  v_lshrrev_b32 v44, 5, v1
  v_lshlrev_b32 v44, 6, v44
  v_add_u32 v40, v40, v44
  v_and_b32 v44, 1, v1
  v_lshlrev_b32 v44, 5, v44
  v_add_u32 v40, v40, v44
  v_bfe_u32 v44, v1, 4, 1
  v_lshlrev_b32 v44, 4, v44
  v_add_u32 v40, v40, v44
  v_bfe_u32 v44, v1, 1, 1
  v_lshlrev_b32 v44, 3, v44
  v_add_u32 v40, v40, v44
  s_lshl_b32 s57, s3, 8
  s_add_u32 s57, s57, 131072
  v_add_u32 v40, s57, v40
  v_lshrrev_b32 v44, 5, v1
  v_lshlrev_b32 v44, 10, v44
  v_and_b32 v45, 31, v1
  v_lshlrev_b32 v45, 4, v45
  v_add_u32 v41, v44, v45
  s_lshl_b32 s57, s56, 12
  s_add_u32 s57, s57, 122880
  v_lshlrev_b32 v42, 3, v1
  v_add_u32 v42, s57, v42
  v_mov_b32 v43, 0x3b000000
  s_lshr_b32 s96, s2, 5
  s_and_b32 s97, s2, 31
  s_and_b32 s98, s3, 1
  v_and_b32 v200, 31, v1
  v_lshrrev_b32 v201, 5, v1
  v_bfe_u32 v202, v200, 2, 1
  v_lshlrev_b32 v202, 4, v202
  v_lshrrev_b32 v203, 3, v200
  v_lshlrev_b32 v203, 2, v203
  v_add_u32 v202, v202, v203
  v_and_b32 v203, 3, v200
  v_add_u32 v202, v202, v203
  s_lshl_b32 s99, s96, 6
  s_lshl_b32 s100, s98, 5
  s_add_u32 s99, s99, s100
  v_add_u32 v202, s99, v202
  s_lshl_b32 s99, s97, 3
  v_lshlrev_b32 v203, 1, v201
  v_add_u32 v203, s99, v203
  v_mov_b32 v204, 0x100
  v_add_u32 v205, 0, v203
  v_cmp_eq_u32 vcc, 0, v205
  s_nop 1
  v_cndmask_b32 v206, v205, v204, vcc
  v_cndmask_b32 v207, 2.0, 1.0, vcc
  v_mul_u32_u24 v206, v206, v202
  v_and_b32 v206, 0x1ff, v206
  v_cvt_f32_u32 v206, v206
  v_mul_f32 v206, 0x3b000000, v206
  v_cos_f32 v208, v206
  v_sin_f32 v209, v206
  v_mul_f32 v208, v208, v207
  v_mul_f32 v209, v209, v207
  v_cvt_pk_bf16_f32 v216, v208, -v209
  v_add_u32 v205, 1, v203
  v_cmp_eq_u32 vcc, 0, v205
  s_nop 1
  v_cndmask_b32 v206, v205, v204, vcc
  v_cndmask_b32 v207, 2.0, 1.0, vcc
  v_mul_u32_u24 v206, v206, v202
  v_and_b32 v206, 0x1ff, v206
  v_cvt_f32_u32 v206, v206
  v_mul_f32 v206, 0x3b000000, v206
  v_cos_f32 v208, v206
  v_sin_f32 v209, v206
  v_mul_f32 v208, v208, v207
  v_mul_f32 v209, v209, v207
  v_cvt_pk_bf16_f32 v217, v208, -v209
  v_add_u32 v205, 4, v203
  v_cmp_eq_u32 vcc, 0, v205
  s_nop 1
  v_cndmask_b32 v206, v205, v204, vcc
  v_cndmask_b32 v207, 2.0, 1.0, vcc
  v_mul_u32_u24 v206, v206, v202
  v_and_b32 v206, 0x1ff, v206
  v_cvt_f32_u32 v206, v206
  v_mul_f32 v206, 0x3b000000, v206
  v_cos_f32 v208, v206
  v_sin_f32 v209, v206
  v_mul_f32 v208, v208, v207
  v_mul_f32 v209, v209, v207
  v_cvt_pk_bf16_f32 v218, v208, -v209
  v_add_u32 v205, 5, v203
  v_cmp_eq_u32 vcc, 0, v205
  s_nop 1
  v_cndmask_b32 v206, v205, v204, vcc
  v_cndmask_b32 v207, 2.0, 1.0, vcc
  v_mul_u32_u24 v206, v206, v202
  v_and_b32 v206, 0x1ff, v206
  v_cvt_f32_u32 v206, v206
  v_mul_f32 v206, 0x3b000000, v206
  v_cos_f32 v208, v206
  v_sin_f32 v209, v206
  v_mul_f32 v208, v208, v207
  v_mul_f32 v209, v209, v207
  v_cvt_pk_bf16_f32 v219, v208, -v209
  s_mul_i32 s99, s96, 144
  s_add_u32 s99, s99, s97
  s_add_u32 s99, s99, 112
  s_lshl_b32 s99, s99, 1
  s_add_u32 s99, s99, s98
  s_lshl_b32 s99, s99, 10
  s_add_u32 s99, s99, 2097152
  v_mul_u32_u24 v220, 144, v1
  s_lshl_b32 s57, s3, 5
  s_add_u32 s57, s57, 139776
  v_add_u32 v220, s57, v220
  v_lshrrev_b32 v223, 3, v1
  s_lshl_b32 s57, s3, 4
  v_add_u32 v223, s57, v223
  v_and_b32 v224, 7, v1
  v_lshlrev_b32 v224, 4, v224
  v_mul_u32_u24 v221, 144, v223
  v_add_u32 v221, v221, v224
  v_add_u32 v221, 139776, v221
  v_lshlrev_b32 v222, 13, v223
  v_add_u32 v222, v222, v224
  s_lshl_b32 s54, s49, 12
  s_lshl_b32 s57, s51, 10
  s_add_u32 s54, s54, s57
  s_lshl_b32 s57, s50, 5
  s_add_u32 s57, s57, s52
  s_lshl_b32 s57, s57, 4
  s_add_u32 s54, s54, s57
  s_add_u32 s54, s54, 9437184
  s_lshl_b32 s57, s47, 19
  s_add_u32 s54, s54, s57
  s_waitcnt vmcnt(26)
  v_lshlrev_b32 v64, 16, v8
  v_and_b32 v65, 0xffff0000, v8
  v_lshlrev_b32 v66, 16, v9
  v_and_b32 v67, 0xffff0000, v9
  v_lshlrev_b32 v68, 16, v10
  v_and_b32 v69, 0xffff0000, v10
  v_lshlrev_b32 v70, 16, v11
  v_and_b32 v71, 0xffff0000, v11
  s_waitcnt vmcnt(25)
  v_lshlrev_b32 v72, 16, v12
  v_and_b32 v73, 0xffff0000, v12
  v_lshlrev_b32 v74, 16, v13
  v_and_b32 v75, 0xffff0000, v13
  v_lshlrev_b32 v76, 16, v14
  v_and_b32 v77, 0xffff0000, v14
  v_lshlrev_b32 v78, 16, v15
  v_and_b32 v79, 0xffff0000, v15
  v_pk_add_f32 v[80:81], v[64:65], v[66:67]
  v_pk_mul_f32 v[82:83], v[64:65], v[64:65]
  v_pk_add_f32 v[84:85], v[72:73], v[74:75]
  v_pk_mul_f32 v[86:87], v[72:73], v[72:73]
  v_pk_fma_f32 v[82:83], v[66:67], v[66:67], v[82:83]
  v_pk_fma_f32 v[86:87], v[74:75], v[74:75], v[86:87]
  v_pk_add_f32 v[80:81], v[80:81], v[68:69]
  v_pk_fma_f32 v[82:83], v[68:69], v[68:69], v[82:83]
  v_pk_add_f32 v[84:85], v[84:85], v[76:77]
  v_pk_fma_f32 v[86:87], v[76:77], v[76:77], v[86:87]
  v_pk_add_f32 v[80:81], v[80:81], v[70:71]
  v_pk_fma_f32 v[82:83], v[70:71], v[70:71], v[82:83]
  v_pk_add_f32 v[84:85], v[84:85], v[78:79]
  v_pk_fma_f32 v[86:87], v[78:79], v[78:79], v[86:87]
  v_add_f32 v80, v80, v81
  v_add_f32 v82, v82, v83
  v_add_f32 v84, v84, v85
  v_add_f32 v86, v86, v87
  v_add_f32_dpp v80, v80, v80 row_shr:1 row_mask:0xf bank_mask:0xf
  v_add_f32_dpp v82, v82, v82 row_shr:1 row_mask:0xf bank_mask:0xf
  v_add_f32_dpp v84, v84, v84 row_shr:1 row_mask:0xf bank_mask:0xf
  v_add_f32_dpp v86, v86, v86 row_shr:1 row_mask:0xf bank_mask:0xf
  v_add_f32_dpp v80, v80, v80 row_shr:2 row_mask:0xf bank_mask:0xf
  v_add_f32_dpp v82, v82, v82 row_shr:2 row_mask:0xf bank_mask:0xf
  v_add_f32_dpp v84, v84, v84 row_shr:2 row_mask:0xf bank_mask:0xf
  v_add_f32_dpp v86, v86, v86 row_shr:2 row_mask:0xf bank_mask:0xf
  v_add_f32_dpp v80, v80, v80 row_shr:4 row_mask:0xf bank_mask:0xf
  v_add_f32_dpp v82, v82, v82 row_shr:4 row_mask:0xf bank_mask:0xf
  v_add_f32_dpp v84, v84, v84 row_shr:4 row_mask:0xf bank_mask:0xf
  v_add_f32_dpp v86, v86, v86 row_shr:4 row_mask:0xf bank_mask:0xf
  v_add_f32_dpp v80, v80, v80 row_shr:8 row_mask:0xf bank_mask:0xf
  v_add_f32_dpp v82, v82, v82 row_shr:8 row_mask:0xf bank_mask:0xf
  v_add_f32_dpp v84, v84, v84 row_shr:8 row_mask:0xf bank_mask:0xf
  v_add_f32_dpp v86, v86, v86 row_shr:8 row_mask:0xf bank_mask:0xf
  v_add_f32_dpp v80, v80, v80 row_bcast:15 row_mask:0xa bank_mask:0xf
  v_add_f32_dpp v82, v82, v82 row_bcast:15 row_mask:0xa bank_mask:0xf
  v_add_f32_dpp v84, v84, v84 row_bcast:15 row_mask:0xa bank_mask:0xf
  v_add_f32_dpp v86, v86, v86 row_bcast:15 row_mask:0xa bank_mask:0xf
  v_add_f32_dpp v80, v80, v80 row_bcast:31 row_mask:0xc bank_mask:0xf
  v_add_f32_dpp v82, v82, v82 row_bcast:31 row_mask:0xc bank_mask:0xf
  v_add_f32_dpp v84, v84, v84 row_bcast:31 row_mask:0xc bank_mask:0xf
  v_add_f32_dpp v86, v86, v86 row_bcast:31 row_mask:0xc bank_mask:0xf
  v_readlane_b32 s71, v80, 63
  v_readlane_b32 s72, v82, 63
  v_readlane_b32 s73, v84, 63
  v_readlane_b32 s74, v86, 63
  v_mul_f32 v88, s71, v43
  v_mul_f32 v89, s72, v43
  v_mul_f32 v96, s73, v43
  v_mul_f32 v97, s74, v43
  v_fma_f32 v89, -v88, v88, v89
  v_fma_f32 v97, -v96, v96, v97
  v_max_f32 v89, 0, v89
  v_max_f32 v97, 0, v97
  v_add_f32 v90, 0x3727c5ac, v89
  v_add_f32 v98, 0x3727c5ac, v97
  v_rsq_f32 v92, v90
  v_rsq_f32 v100, v98
  v_mul_f32 v90, v92, v92
  v_mul_f32 v98, v100, v100
  v_mul_f32 v94, -v88, v92
  v_mul_f32 v90, v90, v89
  v_mul_f32 v102, -v96, v100
  v_mul_f32 v98, v98, v97
  v_add_f32 v90, 0x3727c5ac, v90
  v_add_f32 v98, 0x3727c5ac, v98
  v_rsq_f32 v91, v90
  v_rsq_f32 v99, v98
  v_mov_b32 v93, v92
  v_mov_b32 v95, v94
  v_mov_b32 v101, v100
  v_mov_b32 v103, v102
  v_pk_fma_f32 v[104:105], v[64:65], v[92:93], v[94:95]
  v_pk_fma_f32 v[106:107], v[66:67], v[92:93], v[94:95]
  v_pk_fma_f32 v[108:109], v[68:69], v[92:93], v[94:95]
  v_pk_fma_f32 v[110:111], v[70:71], v[92:93], v[94:95]
  v_cvt_pk_bf16_f32 v8, v104, v105
  v_cvt_pk_bf16_f32 v9, v106, v107
  v_cvt_pk_bf16_f32 v10, v108, v109
  v_cvt_pk_bf16_f32 v11, v110, v111
  ds_write_b128 v2, v[8:11] offset:0
  v_pk_fma_f32 v[120:121], v[72:73], v[100:101], v[102:103]
  v_pk_fma_f32 v[122:123], v[74:75], v[100:101], v[102:103]
  v_pk_fma_f32 v[124:125], v[76:77], v[100:101], v[102:103]
  v_pk_fma_f32 v[126:127], v[78:79], v[100:101], v[102:103]
  v_cvt_pk_bf16_f32 v12, v120, v121
  v_cvt_pk_bf16_f32 v13, v122, v123
  v_cvt_pk_bf16_f32 v14, v124, v125
  v_cvt_pk_bf16_f32 v15, v126, v127
  ds_write_b128 v2, v[12:15] offset:1024
  v_mul_f32 v152, v92, v91
  v_mul_f32 v153, v92, v91
  v_mul_f32 v154, v94, v91
  v_mul_f32 v155, v94, v91
  v_mul_f32 v156, v100, v99
  v_mul_f32 v157, v100, v99
  v_mul_f32 v158, v102, v99
  v_mul_f32 v159, v102, v99
  v_pk_fma_f32 v[112:113], v[64:65], v[152:153], v[154:155]
  v_pk_fma_f32 v[114:115], v[66:67], v[152:153], v[154:155]
  v_pk_fma_f32 v[116:117], v[68:69], v[152:153], v[154:155]
  v_pk_fma_f32 v[118:119], v[70:71], v[152:153], v[154:155]
  v_cvt_pk_bf16_f32 v136, v112, v113
  v_cvt_pk_bf16_f32 v137, v114, v115
  v_cvt_pk_bf16_f32 v138, v116, v117
  v_cvt_pk_bf16_f32 v139, v118, v119
  ds_write_b128 v7, v[136:139] offset:0
  v_pk_fma_f32 v[128:129], v[72:73], v[156:157], v[158:159]
  v_pk_fma_f32 v[130:131], v[74:75], v[156:157], v[158:159]
  v_pk_fma_f32 v[132:133], v[76:77], v[156:157], v[158:159]
  v_pk_fma_f32 v[134:135], v[78:79], v[156:157], v[158:159]
  v_cvt_pk_bf16_f32 v140, v128, v129
  v_cvt_pk_bf16_f32 v141, v130, v131
  v_cvt_pk_bf16_f32 v142, v132, v133
  v_cvt_pk_bf16_f32 v143, v134, v135
  ds_write_b128 v7, v[140:143] offset:1088
  s_waitcnt vmcnt(23)
  v_lshl_or_b32 v196, v173, 16, v172
  s_waitcnt vmcnt(19)
  v_lshl_or_b32 v197, v175, 16, v174
  s_waitcnt vmcnt(15)
  v_lshl_or_b32 v198, v177, 16, v176
  s_waitcnt vmcnt(11)
  v_lshl_or_b32 v199, v179, 16, v178
  ds_write_b128 v220, v[196:199] offset:0
  v_lshl_or_b32 v200, v181, 16, v180
  v_lshl_or_b32 v201, v183, 16, v182
  v_lshl_or_b32 v202, v185, 16, v184
  s_waitcnt vmcnt(9)
  v_lshl_or_b32 v203, v187, 16, v186
  ds_write_b128 v220, v[200:203] offset:16
  s_waitcnt lgkmcnt(0)
  s_barrier
  ds_read_b64_tr_b16 v[64:65], v42 offset:0
  ds_read_b64_tr_b16 v[66:67], v42 offset:512
  ds_read_b64_tr_b16 v[68:69], v42 offset:1024
  ds_read_b64_tr_b16 v[70:71], v42 offset:1536
  ds_read_b64_tr_b16 v[72:73], v42 offset:2048
  ds_read_b64_tr_b16 v[74:75], v42 offset:2560
  ds_read_b64_tr_b16 v[76:77], v42 offset:3072
  ds_read_b64_tr_b16 v[78:79], v42 offset:3584
  ds_read_b64_tr_b16 v[144:145], v40 offset:0
  ds_read_b64_tr_b16 v[146:147], v40 offset:4352
  ds_read_b64_tr_b16 v[148:149], v40 offset:128
  ds_read_b64_tr_b16 v[150:151], v40 offset:4480
  ds_read_b128 v[196:199], v221
  ds_read_b128 v[200:203], v221 offset:1152
  s_waitcnt lgkmcnt(12)
  v_mfma_f32_16x16x32_bf16 v[80:83], v[64:67], v[16:19], 0
  v_mfma_f32_16x16x32_bf16 v[96:99], v[64:67], v[20:23], 0
  s_waitcnt lgkmcnt(10)
  v_mfma_f32_16x16x32_bf16 v[84:87], v[68:71], v[16:19], 0
  v_mfma_f32_16x16x32_bf16 v[100:103], v[68:71], v[20:23], 0
  s_waitcnt lgkmcnt(8)
  v_mfma_f32_16x16x32_bf16 v[88:91], v[72:75], v[16:19], 0
  v_mfma_f32_16x16x32_bf16 v[104:107], v[72:75], v[20:23], 0
  s_waitcnt lgkmcnt(6)
  v_mfma_f32_16x16x32_bf16 v[92:95], v[76:79], v[16:19], 0
  v_mfma_f32_16x16x32_bf16 v[108:111], v[76:79], v[20:23], 0
  s_waitcnt lgkmcnt(4)
  buffer_store_dwordx4 v[144:147], v41, s[28:31], s60 offen sc1
  s_waitcnt lgkmcnt(2)
  buffer_store_dwordx4 v[148:151], v41, s[28:31], s61 offen sc1
  s_add_u32 s57, s54, 65536
  s_waitcnt lgkmcnt(1)
  buffer_store_dwordx4 v[196:199], v222, s[28:31], s54 offen sc1
  s_waitcnt lgkmcnt(0)
  buffer_store_dwordx4 v[200:203], v222, s[28:31], s57 offen sc1
  v_pk_mul_f32 v[120:121], v[96:97], v[32:33]
  v_pk_mul_f32 v[122:123], v[80:81], v[32:33]
  v_pk_fma_f32 v[112:113], v[80:81], v[28:29], v[120:121]
  v_pk_fma_f32 v[116:117], v[96:97], v[28:29], v[122:123] neg_lo:[0,0,1] neg_hi:[0,0,1]
  v_pk_mul_f32 v[120:121], v[98:99], v[34:35]
  v_pk_mul_f32 v[122:123], v[82:83], v[34:35]
  v_pk_fma_f32 v[114:115], v[82:83], v[30:31], v[120:121]
  v_pk_fma_f32 v[118:119], v[98:99], v[30:31], v[122:123] neg_lo:[0,0,1] neg_hi:[0,0,1]
  v_cvt_pk_bf16_f32 v64, v112, v113
  v_cvt_pk_bf16_f32 v65, v114, v115
  v_cvt_pk_bf16_f32 v66, v116, v117
  v_cvt_pk_bf16_f32 v67, v118, v119
  s_nop 1
  v_mfma_f32_16x16x32_bf16 v[124:127], v[24:27], v[64:67], 0
  v_pk_mul_f32 v[160:161], v[100:101], v[32:33]
  v_pk_mul_f32 v[162:163], v[84:85], v[32:33]
  v_pk_fma_f32 v[152:153], v[84:85], v[28:29], v[160:161]
  v_pk_fma_f32 v[156:157], v[100:101], v[28:29], v[162:163] neg_lo:[0,0,1] neg_hi:[0,0,1]
  v_pk_mul_f32 v[160:161], v[102:103], v[34:35]
  v_pk_mul_f32 v[162:163], v[86:87], v[34:35]
  v_pk_fma_f32 v[154:155], v[86:87], v[30:31], v[160:161]
  v_pk_fma_f32 v[158:159], v[102:103], v[30:31], v[162:163] neg_lo:[0,0,1] neg_hi:[0,0,1]
  v_cvt_pk_bf16_f32 v68, v152, v153
  v_cvt_pk_bf16_f32 v69, v154, v155
  v_cvt_pk_bf16_f32 v70, v156, v157
  v_cvt_pk_bf16_f32 v71, v158, v159
  s_nop 1
  v_mfma_f32_16x16x32_bf16 v[128:131], v[24:27], v[68:71], 0
  v_pk_mul_f32 v[120:121], v[104:105], v[32:33]
  v_pk_mul_f32 v[122:123], v[88:89], v[32:33]
  v_pk_fma_f32 v[112:113], v[88:89], v[28:29], v[120:121]
  v_pk_fma_f32 v[116:117], v[104:105], v[28:29], v[122:123] neg_lo:[0,0,1] neg_hi:[0,0,1]
  v_pk_mul_f32 v[120:121], v[106:107], v[34:35]
  v_pk_mul_f32 v[122:123], v[90:91], v[34:35]
  v_pk_fma_f32 v[114:115], v[90:91], v[30:31], v[120:121]
  v_pk_fma_f32 v[118:119], v[106:107], v[30:31], v[122:123] neg_lo:[0,0,1] neg_hi:[0,0,1]
  v_cvt_pk_bf16_f32 v72, v112, v113
  v_cvt_pk_bf16_f32 v73, v114, v115
  v_cvt_pk_bf16_f32 v74, v116, v117
  v_cvt_pk_bf16_f32 v75, v118, v119
  s_nop 1
  v_mfma_f32_16x16x32_bf16 v[132:135], v[24:27], v[72:75], 0
  v_pk_mul_f32 v[160:161], v[108:109], v[32:33]
  v_pk_mul_f32 v[162:163], v[92:93], v[32:33]
  v_pk_fma_f32 v[152:153], v[92:93], v[28:29], v[160:161]
  v_pk_fma_f32 v[156:157], v[108:109], v[28:29], v[162:163] neg_lo:[0,0,1] neg_hi:[0,0,1]
  v_pk_mul_f32 v[160:161], v[110:111], v[34:35]
  v_pk_mul_f32 v[162:163], v[94:95], v[34:35]
  v_pk_fma_f32 v[154:155], v[94:95], v[30:31], v[160:161]
  v_pk_fma_f32 v[158:159], v[110:111], v[30:31], v[162:163] neg_lo:[0,0,1] neg_hi:[0,0,1]
  v_cvt_pk_bf16_f32 v76, v152, v153
  v_cvt_pk_bf16_f32 v77, v154, v155
  v_cvt_pk_bf16_f32 v78, v156, v157
  v_cvt_pk_bf16_f32 v79, v158, v159
  s_nop 1
  v_mfma_f32_16x16x32_bf16 v[136:139], v[24:27], v[76:79], 0
  v_cvt_pk_bf16_f32 v144, v124, v128
  s_nop 6
  v_cvt_pk_bf16_f32 v145, v132, v136
  ds_write_b64 v36, v[144:145] offset:0
  v_cvt_pk_bf16_f32 v146, v125, v129
  v_cvt_pk_bf16_f32 v147, v133, v137
  v_xor_b32 v146, v38, v146
  v_xor_b32 v147, v38, v147
  ds_write_b64 v36, v[146:147] offset:16
  v_cvt_pk_bf16_f32 v148, v126, v130
  v_cvt_pk_bf16_f32 v149, v134, v138
  ds_write_b64 v37, v[148:149] offset:0
  v_cvt_pk_bf16_f32 v150, v127, v131
  v_cvt_pk_bf16_f32 v151, v135, v139
  v_xor_b32 v150, v39, v150
  v_xor_b32 v151, v39, v151
  ds_write_b64 v37, v[150:151] offset:16
  s_cmp_lt_u32 s3, 2
  s_cselect_b32 s99, s99, 268435456
  buffer_store_dwordx4 v[216:219], v3, s[28:31], s99 offen sc1
  s_lshl_b32 s57, s3, 11
  s_add_u32 s57, s57, 148992
  v_add_u32 v2, s57, v3
  s_lshl_b32 s57, s44, 13
  s_lshl_b32 s96, s3, 11
  s_add_u32 s57, s57, s96
  s_add_u32 s57, s57, 5242880
  s_waitcnt lgkmcnt(0)
  s_barrier
  ds_read_b128 v[64:67], v2
  ds_read_b128 v[68:71], v2 offset:1024
  s_waitcnt lgkmcnt(1)
  buffer_store_dwordx4 v[64:67], v3, s[28:31], s57 offen sc1
  s_waitcnt lgkmcnt(0)
  buffer_store_dwordx4 v[68:71], v3, s[28:31], s57 offen offset:1024 sc1
  s_mov_b32 s40, s62
  s_and_b32 s41, s63, 0xffff
  s_mov_b32 s42, 256
  s_mov_b32 s43, 0x20000
  v_mov_b32 v250, 0
  buffer_load_dword v251, v250, s[40:43], 0 offen sc1
  s_mov_b32 s32, s12
  s_and_b32 s33, s13, 0xffff
  s_mov_b32 s34, 7340032
  s_mov_b32 s35, 0x20000
  buffer_load_dwordx4 v[192:195], v189, s[32:35], s101 offen
  s_add_u32 s101, s101, 3584
  buffer_load_dwordx4 v[192:195], v189, s[32:35], s101 offen
  s_add_u32 s101, s101, 3584
  buffer_load_dwordx4 v[192:195], v189, s[32:35], s101 offen
  s_add_u32 s101, s101, 3584
  buffer_load_dwordx4 v[192:195], v189, s[32:35], s101 offen
  s_add_u32 s101, s101, 3584
  buffer_load_dwordx4 v[192:195], v189, s[32:35], s101 offen
  s_add_u32 s101, s101, 3584
  buffer_load_dwordx4 v[192:195], v189, s[32:35], s101 offen
  s_add_u32 s101, s101, 3584
  buffer_load_dwordx4 v[192:195], v189, s[32:35], s101 offen
  s_add_u32 s101, s101, 3584
  buffer_load_dwordx4 v[192:195], v189, s[32:35], s101 offen
  s_add_u32 s101, s101, 3584
  s_cmp_lt_u32 s65, 4
  s_cbranch_scc1 fz_fft
  s_sub_u32 s44, s65, 4
  s_and_b32 s66, s64, 1
  s_lshl_b32 s66, s66, 2
  s_and_b32 s45, s44, 3
  s_add_u32 s66, s66, s45
  s_lshr_b32 s67, s64, 1
  s_mul_i32 s67, s67, 7
  s_lshr_b32 s45, s44, 2
  s_add_u32 s67, s67, s45
  v_lshrrev_b32 v8, 3, v1
  v_and_b32 v9, 7, v1
  v_bfe_u32 v10, v1, 4, 1
  v_lshlrev_b32 v10, 2, v10
  v_xor_b32 v9, v9, v10
  v_lshlrev_b32 v9, 4, v9
  s_mov_b32 s60, 3584
  v_mul_lo_u32 v8, v8, s60
  v_add_u32 v224, v8, v9
  v_add_u32 v225, 27648, v224
  v_lshrrev_b32 v8, 5, v1
  v_mul_u32_u24 v8, 1024, v8
  v_bfe_u32 v9, v1, 2, 2
  v_lshlrev_b32 v9, 7, v9
  v_add_u32 v8, v8, v9
  v_bfe_u32 v9, v1, 4, 1
  v_lshlrev_b32 v9, 5, v9
  v_add_u32 v8, v8, v9
  v_and_b32 v9, 3, v1
  v_lshlrev_b32 v9, 3, v9
  v_add_u32 v8, v8, v9
  v_bfe_u32 v9, v1, 3, 1
  v_lshlrev_b32 v9, 6, v9
  v_xor_b32 v226, v8, v9
  s_lshr_b32 s45, s3, 1
  s_lshl_b32 s45, s45, 6
  v_xor_b32 v226, s45, v226
  s_mul_i32 s50, s3, 30720
  v_add_u32 v226, s50, v226
  v_xor_b32 v227, 64, v226
  s_mul_i32 s51, s3, 1835008
  s_lshl_b32 s52, s67, 7
  s_add_u32 s51, s51, s52
  s_mov_b32 s24, s12
  s_and_b32 s25, s13, 0xffff
  s_mov_b32 s26, 7340032
  s_mov_b32 s27, 0x20000
  s_add_u32 m0, s50, 0
  s_nop 0
  buffer_load_dwordx4 v224, s[24:27], s51 offen  lds
  buffer_load_dwordx4 v225, s[24:27], s51 offen offset:1024  lds
  s_add_u32 s51, s51, 57344
  s_add_u32 m0, s50, 2048
  s_nop 0
  buffer_load_dwordx4 v224, s[24:27], s51 offen  lds
  buffer_load_dwordx4 v225, s[24:27], s51 offen offset:1024  lds
  s_add_u32 s51, s51, 57344
  s_waitcnt vmcnt(12)
  s_barrier
  s_cmp_lg_u32 s3, 0
  s_cbranch_scc1 fzg_siga_skip
  s_mov_b32 s73, 0
  s_mov_b64 exec, 1
fzg_rdy:
  v_cmp_ne_u32 vcc, 0, v251
  s_nop 2
  s_cmp_eq_u64 vcc, exec
  s_cbranch_scc1 fzg_rdy_done
  buffer_load_dword v251, v250, s[40:43], 0 offen sc1
  s_add_u32 s73, s73, 1
  s_waitcnt vmcnt(0)
  s_cmp_lt_u32 s73, 131072
  s_cbranch_scc1 fzg_rdy
fzg_rdy_done:
  s_and_b32 s72, s2, 31
  s_lshl_b32 s72, s72, 7
  s_add_u32 s72, s72, 12582912
  v_mov_b32 v251, 1
  buffer_atomic_add v251, v250, s[28:31], s72 offen sc1
  s_mov_b64 exec, -1
fzg_siga_skip:
  s_add_u32 m0, s50, 4096
  s_nop 0
  buffer_load_dwordx4 v224, s[24:27], s51 offen  lds
  buffer_load_dwordx4 v225, s[24:27], s51 offen offset:1024  lds
  s_add_u32 s51, s51, 57344
  s_add_u32 m0, s50, 6144
  s_nop 0
  buffer_load_dwordx4 v224, s[24:27], s51 offen  lds
  buffer_load_dwordx4 v225, s[24:27], s51 offen offset:1024  lds
  s_add_u32 s51, s51, 57344
  s_add_u32 m0, s50, 8192
  s_nop 0
  buffer_load_dwordx4 v224, s[24:27], s51 offen  lds
  buffer_load_dwordx4 v225, s[24:27], s51 offen offset:1024  lds
  s_add_u32 s51, s51, 57344
  s_add_u32 m0, s50, 10240
  s_nop 0
  buffer_load_dwordx4 v224, s[24:27], s51 offen  lds
  buffer_load_dwordx4 v225, s[24:27], s51 offen offset:1024  lds
  s_add_u32 s51, s51, 57344
  s_add_u32 m0, s50, 12288
  s_nop 0
  buffer_load_dwordx4 v224, s[24:27], s51 offen  lds
  buffer_load_dwordx4 v225, s[24:27], s51 offen offset:1024  lds
  s_add_u32 s51, s51, 57344
  s_add_u32 m0, s50, 14336
  s_nop 0
  buffer_load_dwordx4 v224, s[24:27], s51 offen  lds
  buffer_load_dwordx4 v225, s[24:27], s51 offen offset:1024  lds
  s_add_u32 s51, s51, 57344
  s_add_u32 m0, s50, 16384
  s_nop 0
  buffer_load_dwordx4 v224, s[24:27], s51 offen  lds
  buffer_load_dwordx4 v225, s[24:27], s51 offen offset:1024  lds
  s_add_u32 s51, s51, 57344
  s_add_u32 m0, s50, 18432
  s_nop 0
  buffer_load_dwordx4 v224, s[24:27], s51 offen  lds
  buffer_load_dwordx4 v225, s[24:27], s51 offen offset:1024  lds
  s_add_u32 s51, s51, 57344
  s_add_u32 m0, s50, 20480
  s_nop 0
  buffer_load_dwordx4 v224, s[24:27], s51 offen  lds
  buffer_load_dwordx4 v225, s[24:27], s51 offen offset:1024  lds
  s_add_u32 s51, s51, 57344
  s_add_u32 m0, s50, 22528
  s_nop 0
  buffer_load_dwordx4 v224, s[24:27], s51 offen  lds
  buffer_load_dwordx4 v225, s[24:27], s51 offen offset:1024  lds
  s_add_u32 s51, s51, 57344
  s_add_u32 m0, s50, 24576
  s_nop 0
  buffer_load_dwordx4 v224, s[24:27], s51 offen  lds
  buffer_load_dwordx4 v225, s[24:27], s51 offen offset:1024  lds
  s_add_u32 s51, s51, 57344
  s_add_u32 m0, s50, 26624
  s_nop 0
  buffer_load_dwordx4 v224, s[24:27], s51 offen  lds
  buffer_load_dwordx4 v225, s[24:27], s51 offen offset:1024  lds
  s_add_u32 s51, s51, 57344
  s_add_u32 m0, s50, 28672
  s_nop 0
  buffer_load_dwordx4 v224, s[24:27], s51 offen  lds
  buffer_load_dwordx4 v225, s[24:27], s51 offen offset:1024  lds
  s_add_u32 s51, s51, 57344
  s_waitcnt vmcnt(28)
  ds_read_b64_tr_b16 a[0:1], v226 offset:0
  ds_read_b64_tr_b16 a[2:3], v226 offset:512
  ds_read_b64_tr_b16 a[4:5], v227 offset:0
  ds_read_b64_tr_b16 a[6:7], v227 offset:512
  s_waitcnt vmcnt(26)
  ds_read_b64_tr_b16 a[8:9], v226 offset:2048
  ds_read_b64_tr_b16 a[10:11], v226 offset:2560
  ds_read_b64_tr_b16 a[12:13], v227 offset:2048
  ds_read_b64_tr_b16 a[14:15], v227 offset:2560
  s_waitcnt lgkmcnt(4)
  s_add_u32 m0, s50, 0
  s_nop 0
  buffer_load_dwordx4 v224, s[24:27], s51 offen  lds
  buffer_load_dwordx4 v225, s[24:27], s51 offen offset:1024  lds
  s_add_u32 s51, s51, 57344
  s_waitcnt vmcnt(26)
  ds_read_b64_tr_b16 a[16:17], v226 offset:4096
  ds_read_b64_tr_b16 a[18:19], v226 offset:4608
  ds_read_b64_tr_b16 a[20:21], v227 offset:4096
  ds_read_b64_tr_b16 a[22:23], v227 offset:4608
  s_waitcnt lgkmcnt(4)
  s_add_u32 m0, s50, 2048
  s_nop 0
  buffer_load_dwordx4 v224, s[24:27], s51 offen  lds
  buffer_load_dwordx4 v225, s[24:27], s51 offen offset:1024  lds
  s_add_u32 s51, s51, 57344
  s_waitcnt vmcnt(26)
  ds_read_b64_tr_b16 a[24:25], v226 offset:6144
  ds_read_b64_tr_b16 a[26:27], v226 offset:6656
  ds_read_b64_tr_b16 a[28:29], v227 offset:6144
  ds_read_b64_tr_b16 a[30:31], v227 offset:6656
  s_waitcnt lgkmcnt(4)
  s_add_u32 m0, s50, 4096
  s_nop 0
  buffer_load_dwordx4 v224, s[24:27], s51 offen  lds
  buffer_load_dwordx4 v225, s[24:27], s51 offen offset:1024  lds
  s_add_u32 s51, s51, 57344
  s_waitcnt vmcnt(26)
  ds_read_b64_tr_b16 a[32:33], v226 offset:8192
  ds_read_b64_tr_b16 a[34:35], v226 offset:8704
  ds_read_b64_tr_b16 a[36:37], v227 offset:8192
  ds_read_b64_tr_b16 a[38:39], v227 offset:8704
  s_waitcnt lgkmcnt(4)
  s_add_u32 m0, s50, 6144
  s_nop 0
  buffer_load_dwordx4 v224, s[24:27], s51 offen  lds
  buffer_load_dwordx4 v225, s[24:27], s51 offen offset:1024  lds
  s_add_u32 s51, s51, 57344
  s_waitcnt vmcnt(26)
  ds_read_b64_tr_b16 a[40:41], v226 offset:10240
  ds_read_b64_tr_b16 a[42:43], v226 offset:10752
  ds_read_b64_tr_b16 a[44:45], v227 offset:10240
  ds_read_b64_tr_b16 a[46:47], v227 offset:10752
  s_waitcnt lgkmcnt(4)
  s_add_u32 m0, s50, 8192
  s_nop 0
  buffer_load_dwordx4 v224, s[24:27], s51 offen  lds
  buffer_load_dwordx4 v225, s[24:27], s51 offen offset:1024  lds
  s_add_u32 s51, s51, 57344
  s_waitcnt vmcnt(26)
  ds_read_b64_tr_b16 a[48:49], v226 offset:12288
  ds_read_b64_tr_b16 a[50:51], v226 offset:12800
  ds_read_b64_tr_b16 a[52:53], v227 offset:12288
  ds_read_b64_tr_b16 a[54:55], v227 offset:12800
  s_waitcnt lgkmcnt(4)
  s_add_u32 m0, s50, 10240
  s_nop 0
  buffer_load_dwordx4 v224, s[24:27], s51 offen  lds
  buffer_load_dwordx4 v225, s[24:27], s51 offen offset:1024  lds
  s_add_u32 s51, s51, 57344
  s_waitcnt vmcnt(26)
  ds_read_b64_tr_b16 a[56:57], v226 offset:14336
  ds_read_b64_tr_b16 a[58:59], v226 offset:14848
  ds_read_b64_tr_b16 a[60:61], v227 offset:14336
  ds_read_b64_tr_b16 a[62:63], v227 offset:14848
  s_waitcnt lgkmcnt(4)
  s_add_u32 m0, s50, 12288
  s_nop 0
  buffer_load_dwordx4 v224, s[24:27], s51 offen  lds
  buffer_load_dwordx4 v225, s[24:27], s51 offen offset:1024  lds
  s_add_u32 s51, s51, 57344
  s_waitcnt vmcnt(26)
  ds_read_b64_tr_b16 a[64:65], v226 offset:16384
  ds_read_b64_tr_b16 a[66:67], v226 offset:16896
  ds_read_b64_tr_b16 a[68:69], v227 offset:16384
  ds_read_b64_tr_b16 a[70:71], v227 offset:16896
  s_waitcnt lgkmcnt(4)
  s_add_u32 m0, s50, 14336
  s_nop 0
  buffer_load_dwordx4 v224, s[24:27], s51 offen  lds
  buffer_load_dwordx4 v225, s[24:27], s51 offen offset:1024  lds
  s_add_u32 s51, s51, 57344
  s_waitcnt vmcnt(26)
  ds_read_b64_tr_b16 a[72:73], v226 offset:18432
  ds_read_b64_tr_b16 a[74:75], v226 offset:18944
  ds_read_b64_tr_b16 a[76:77], v227 offset:18432
  ds_read_b64_tr_b16 a[78:79], v227 offset:18944
  s_waitcnt lgkmcnt(4)
  s_add_u32 m0, s50, 16384
  s_nop 0
  buffer_load_dwordx4 v224, s[24:27], s51 offen  lds
  buffer_load_dwordx4 v225, s[24:27], s51 offen offset:1024  lds
  s_add_u32 s51, s51, 57344
  s_waitcnt vmcnt(26)
  ds_read_b64_tr_b16 a[80:81], v226 offset:20480
  ds_read_b64_tr_b16 a[82:83], v226 offset:20992
  ds_read_b64_tr_b16 a[84:85], v227 offset:20480
  ds_read_b64_tr_b16 a[86:87], v227 offset:20992
  s_waitcnt lgkmcnt(4)
  s_add_u32 m0, s50, 18432
  s_nop 0
  buffer_load_dwordx4 v224, s[24:27], s51 offen  lds
  buffer_load_dwordx4 v225, s[24:27], s51 offen offset:1024  lds
  s_add_u32 s51, s51, 57344
  s_waitcnt vmcnt(26)
  ds_read_b64_tr_b16 a[88:89], v226 offset:22528
  ds_read_b64_tr_b16 a[90:91], v226 offset:23040
  ds_read_b64_tr_b16 a[92:93], v227 offset:22528
  ds_read_b64_tr_b16 a[94:95], v227 offset:23040
  s_waitcnt lgkmcnt(4)
  s_add_u32 m0, s50, 20480
  s_nop 0
  buffer_load_dwordx4 v224, s[24:27], s51 offen  lds
  buffer_load_dwordx4 v225, s[24:27], s51 offen offset:1024  lds
  s_add_u32 s51, s51, 57344
  s_waitcnt vmcnt(26)
  ds_read_b64_tr_b16 a[96:97], v226 offset:24576
  ds_read_b64_tr_b16 a[98:99], v226 offset:25088
  ds_read_b64_tr_b16 a[100:101], v227 offset:24576
  ds_read_b64_tr_b16 a[102:103], v227 offset:25088
  s_waitcnt lgkmcnt(4)
  s_add_u32 m0, s50, 22528
  s_nop 0
  buffer_load_dwordx4 v224, s[24:27], s51 offen  lds
  buffer_load_dwordx4 v225, s[24:27], s51 offen offset:1024  lds
  s_add_u32 s51, s51, 57344
  s_waitcnt vmcnt(26)
  ds_read_b64_tr_b16 a[104:105], v226 offset:26624
  ds_read_b64_tr_b16 a[106:107], v226 offset:27136
  ds_read_b64_tr_b16 a[108:109], v227 offset:26624
  ds_read_b64_tr_b16 a[110:111], v227 offset:27136
  s_waitcnt lgkmcnt(4)
  s_add_u32 m0, s50, 24576
  s_nop 0
  buffer_load_dwordx4 v224, s[24:27], s51 offen  lds
  buffer_load_dwordx4 v225, s[24:27], s51 offen offset:1024  lds
  s_add_u32 s51, s51, 57344
  s_waitcnt vmcnt(26)
  ds_read_b64_tr_b16 a[112:113], v226 offset:28672
  ds_read_b64_tr_b16 a[114:115], v226 offset:29184
  ds_read_b64_tr_b16 a[116:117], v227 offset:28672
  ds_read_b64_tr_b16 a[118:119], v227 offset:29184
  s_waitcnt lgkmcnt(4)
  s_add_u32 m0, s50, 26624
  s_nop 0
  buffer_load_dwordx4 v224, s[24:27], s51 offen  lds
  buffer_load_dwordx4 v225, s[24:27], s51 offen offset:1024  lds
  s_add_u32 s51, s51, 57344
  s_waitcnt vmcnt(26)
  ds_read_b64_tr_b16 a[120:121], v226 offset:0
  ds_read_b64_tr_b16 a[122:123], v226 offset:512
  ds_read_b64_tr_b16 a[124:125], v227 offset:0
  ds_read_b64_tr_b16 a[126:127], v227 offset:512
  s_waitcnt lgkmcnt(4)
  s_add_u32 m0, s50, 28672
  s_nop 0
  buffer_load_dwordx4 v224, s[24:27], s51 offen  lds
  buffer_load_dwordx4 v225, s[24:27], s51 offen offset:1024  lds
  s_add_u32 s51, s51, 57344
  s_waitcnt vmcnt(26)
  ds_read_b64_tr_b16 a[128:129], v226 offset:2048
  ds_read_b64_tr_b16 a[130:131], v226 offset:2560
  ds_read_b64_tr_b16 a[132:133], v227 offset:2048
  ds_read_b64_tr_b16 a[134:135], v227 offset:2560
  s_waitcnt lgkmcnt(4)
  s_add_u32 m0, s50, 0
  s_nop 0
  buffer_load_dwordx4 v224, s[24:27], s51 offen  lds
  buffer_load_dwordx4 v225, s[24:27], s51 offen offset:1024  lds
  s_add_u32 s51, s51, 57344
  s_waitcnt vmcnt(26)
  ds_read_b64_tr_b16 a[136:137], v226 offset:4096
  ds_read_b64_tr_b16 a[138:139], v226 offset:4608
  ds_read_b64_tr_b16 a[140:141], v227 offset:4096
  ds_read_b64_tr_b16 a[142:143], v227 offset:4608
  s_waitcnt lgkmcnt(4)
  s_add_u32 m0, s50, 2048
  s_nop 0
  buffer_load_dwordx4 v224, s[24:27], s51 offen  lds
  buffer_load_dwordx4 v225, s[24:27], s51 offen offset:1024  lds
  s_add_u32 s51, s51, 57344
  s_waitcnt vmcnt(26)
  ds_read_b64_tr_b16 a[144:145], v226 offset:6144
  ds_read_b64_tr_b16 a[146:147], v226 offset:6656
  ds_read_b64_tr_b16 a[148:149], v227 offset:6144
  ds_read_b64_tr_b16 a[150:151], v227 offset:6656
  s_waitcnt vmcnt(24)
  ds_read_b64_tr_b16 a[152:153], v226 offset:8192
  ds_read_b64_tr_b16 a[154:155], v226 offset:8704
  ds_read_b64_tr_b16 a[156:157], v227 offset:8192
  ds_read_b64_tr_b16 a[158:159], v227 offset:8704
  s_waitcnt vmcnt(22)
  ds_read_b64_tr_b16 a[160:161], v226 offset:10240
  ds_read_b64_tr_b16 a[162:163], v226 offset:10752
  ds_read_b64_tr_b16 a[164:165], v227 offset:10240
  ds_read_b64_tr_b16 a[166:167], v227 offset:10752
  s_waitcnt vmcnt(20)
  ds_read_b64_tr_b16 a[168:169], v226 offset:12288
  ds_read_b64_tr_b16 a[170:171], v226 offset:12800
  ds_read_b64_tr_b16 a[172:173], v227 offset:12288
  ds_read_b64_tr_b16 a[174:175], v227 offset:12800
  s_waitcnt vmcnt(18)
  ds_read_b64_tr_b16 a[176:177], v226 offset:14336
  ds_read_b64_tr_b16 a[178:179], v226 offset:14848
  ds_read_b64_tr_b16 a[180:181], v227 offset:14336
  ds_read_b64_tr_b16 a[182:183], v227 offset:14848
  s_waitcnt vmcnt(16)
  ds_read_b64_tr_b16 a[184:185], v226 offset:16384
  ds_read_b64_tr_b16 a[186:187], v226 offset:16896
  ds_read_b64_tr_b16 a[188:189], v227 offset:16384
  ds_read_b64_tr_b16 a[190:191], v227 offset:16896
  s_waitcnt vmcnt(14)
  ds_read_b64_tr_b16 a[192:193], v226 offset:18432
  ds_read_b64_tr_b16 a[194:195], v226 offset:18944
  ds_read_b64_tr_b16 a[196:197], v227 offset:18432
  ds_read_b64_tr_b16 a[198:199], v227 offset:18944
  s_waitcnt vmcnt(12)
  ds_read_b64_tr_b16 a[200:201], v226 offset:20480
  ds_read_b64_tr_b16 a[202:203], v226 offset:20992
  ds_read_b64_tr_b16 a[204:205], v227 offset:20480
  ds_read_b64_tr_b16 a[206:207], v227 offset:20992
  s_waitcnt vmcnt(10)
  ds_read_b64_tr_b16 a[208:209], v226 offset:22528
  ds_read_b64_tr_b16 a[210:211], v226 offset:23040
  ds_read_b64_tr_b16 a[212:213], v227 offset:22528
  ds_read_b64_tr_b16 a[214:215], v227 offset:23040
  s_waitcnt vmcnt(8)
  ds_read_b64_tr_b16 a[216:217], v226 offset:24576
  ds_read_b64_tr_b16 a[218:219], v226 offset:25088
  ds_read_b64_tr_b16 a[220:221], v227 offset:24576
  ds_read_b64_tr_b16 a[222:223], v227 offset:25088
  s_waitcnt vmcnt(6)
  ds_read_b64_tr_b16 a[224:225], v226 offset:26624
  ds_read_b64_tr_b16 a[226:227], v226 offset:27136
  ds_read_b64_tr_b16 a[228:229], v227 offset:26624
  ds_read_b64_tr_b16 a[230:231], v227 offset:27136
  s_waitcnt vmcnt(4)
  ds_read_b64_tr_b16 a[232:233], v226 offset:28672
  ds_read_b64_tr_b16 a[234:235], v226 offset:29184
  ds_read_b64_tr_b16 a[236:237], v227 offset:28672
  ds_read_b64_tr_b16 a[238:239], v227 offset:29184
  s_waitcnt vmcnt(2)
  ds_read_b64_tr_b16 a[240:241], v226 offset:0
  ds_read_b64_tr_b16 a[242:243], v226 offset:512
  ds_read_b64_tr_b16 a[244:245], v227 offset:0
  ds_read_b64_tr_b16 a[246:247], v227 offset:512
  s_waitcnt vmcnt(0)
  ds_read_b64_tr_b16 a[248:249], v226 offset:2048
  ds_read_b64_tr_b16 a[250:251], v226 offset:2560
  ds_read_b64_tr_b16 a[252:253], v227 offset:2048
  ds_read_b64_tr_b16 a[254:255], v227 offset:2560
  s_waitcnt lgkmcnt(0)
  s_cmp_lg_u32 s3, 0
  s_cbranch_scc1 fz_pa_skip
  v_lshlrev_b32 v250, 7, v1
  v_mov_b32 v251, 8
  s_mov_b32 s72, 12582912
  s_mov_b32 s73, 0
  s_mov_b32 exec_lo, 0xffffffff
  s_mov_b32 exec_hi, 0
fz_pa_loop:
  buffer_load_dword v252, v250, s[28:31], s72 offen sc1
  s_add_u32 s73, s73, 1
  s_waitcnt vmcnt(0)
  v_cmp_ge_u32 vcc, v252, v251
  s_nop 2
  s_cmp_eq_u64 vcc, exec
  s_cbranch_scc1 fz_pa_done
  s_cmp_lt_u32 s73, 131072
  s_cbranch_scc1 fz_pa_loop
fz_pa_done:
  s_mov_b64 exec, -1
fz_pa_skip:
  s_barrier
  v_lshlrev_b32 v8, 4, v1
  s_and_b32 s48, s3, 1
  s_lshr_b32 s47, s3, 1
  s_lshl_b32 s49, s48, 10
  v_add_u32 v4, s49, v8
  s_xor_b32 s49, s49, 1024
  v_add_u32 v7, s49, v8
  s_lshl_b32 s52, s66, 18
  s_lshl_b32 s53, s3, 16
  s_add_u32 s52, s52, s53
  s_add_u32 s52, s52, 0
  buffer_load_dwordx4 v[128:131], v4, s[28:31], s52 offen sc1
  buffer_load_dwordx4 v[132:135], v7, s[28:31], s52 offen sc1
  s_add_u32 s52, s52, 2048
  buffer_load_dwordx4 v[136:139], v4, s[28:31], s52 offen sc1
  buffer_load_dwordx4 v[140:143], v7, s[28:31], s52 offen sc1
  s_add_u32 s52, s52, 2048
  buffer_load_dwordx4 v[144:147], v4, s[28:31], s52 offen sc1
  buffer_load_dwordx4 v[148:151], v7, s[28:31], s52 offen sc1
  s_add_u32 s52, s52, 2048
  buffer_load_dwordx4 v[152:155], v4, s[28:31], s52 offen sc1
  buffer_load_dwordx4 v[156:159], v7, s[28:31], s52 offen sc1
  s_add_u32 s52, s52, 2048
  buffer_load_dwordx4 v[160:163], v4, s[28:31], s52 offen sc1
  buffer_load_dwordx4 v[164:167], v7, s[28:31], s52 offen sc1
  s_add_u32 s52, s52, 2048
  buffer_load_dwordx4 v[168:171], v4, s[28:31], s52 offen sc1
  buffer_load_dwordx4 v[172:175], v7, s[28:31], s52 offen sc1
  s_add_u32 s52, s52, 2048
  buffer_load_dwordx4 v[176:179], v4, s[28:31], s52 offen sc1
  buffer_load_dwordx4 v[180:183], v7, s[28:31], s52 offen sc1
  s_add_u32 s52, s52, 2048
  buffer_load_dwordx4 v[184:187], v4, s[28:31], s52 offen sc1
  buffer_load_dwordx4 v[188:191], v7, s[28:31], s52 offen sc1
  s_add_u32 s52, s52, 2048
  v_lshrrev_b32 v13, 5, v1
  v_lshlrev_b32 v13, 3, v13
  s_lshl_b32 s56, s67, 7
  s_lshl_b32 s54, s47, 6
  s_add_u32 s56, s56, s54
  s_mov_b32 s32, s14
  s_and_b32 s33, s15, 0xffff
  s_mov_b32 s34, 3584
  s_mov_b32 s35, 0x20000
  buffer_load_dwordx2 v[16:17], v13, s[32:35], s56 offen offset:0
  buffer_load_dwordx2 v[18:19], v13, s[32:35], s56 offen offset:16
  buffer_load_dwordx2 v[20:21], v13, s[32:35], s56 offen offset:32
  buffer_load_dwordx2 v[22:23], v13, s[32:35], s56 offen offset:48
  s_and_b32 s68, s65, 7
  s_lshl_b32 s69, s64, 2
  s_lshr_b32 s44, s65, 3
  s_add_u32 s69, s69, s44
  v_lshrrev_b32 v24, 3, v1
  v_and_b32 v25, 7, v1
  v_bfe_u32 v26, v1, 4, 1
  v_lshlrev_b32 v26, 2, v26
  v_xor_b32 v25, v25, v26
  v_lshlrev_b32 v25, 4, v25
  v_lshlrev_b32 v24, 12, v24
  v_add_u32 v28, v24, v25
  v_add_u32 v29, 31744, v28
  v_lshrrev_b32 v24, 5, v1
  v_lshlrev_b32 v24, 9, v24
  v_bfe_u32 v25, v1, 2, 2
  v_lshlrev_b32 v25, 7, v25
  v_add_u32 v24, v24, v25
  v_bfe_u32 v25, v1, 4, 1
  v_lshlrev_b32 v25, 5, v25
  v_add_u32 v24, v24, v25
  v_and_b32 v25, 3, v1
  v_lshlrev_b32 v25, 3, v25
  v_add_u32 v24, v24, v25
  v_bfe_u32 v25, v1, 3, 1
  v_lshlrev_b32 v25, 6, v25
  v_xor_b32 v30, v24, v25
  s_and_b32 s45, s3, 1
  s_lshl_b32 s44, s45, 6
  v_xor_b32 v30, s44, v30
  s_mul_i32 s98, s3, 28672
  s_add_u32 s98, s98, 49152
  v_add_u32 v30, s98, v30
  v_xor_b32 v31, 64, v30
  s_mul_i32 s99, s3, 1835008
  s_lshl_b32 s44, s69, 7
  s_add_u32 s99, s99, s44
  s_mov_b32 s24, s16
  s_and_b32 s25, s17, 0xffff
  s_mov_b32 s26, 7340032
  s_mov_b32 s27, 0x20000
  s_and_b32 s45, s3, 1
  s_lshr_b32 s46, s3, 1
  s_lshl_b32 s44, s69, 7
  s_lshl_b32 s51, s3, 19
  s_add_u32 s51, s51, s44
  s_add_u32 s51, s51, 7340032
  v_lshlrev_b32 v8, 4, v1
  s_lshl_b32 s44, s46, 10
  v_add_u32 v48, s44, v8
  s_xor_b32 s44, s44, 1024
  v_add_u32 v49, s44, v8
  s_mul_i32 s44, s68, 144
  s_lshl_b32 s97, s3, 3
  s_add_u32 s97, s97, s44
  s_add_u32 s97, s97, 112
  s_lshl_b32 s97, s97, 11
  s_add_u32 s97, s97, 2097152
  s_mul_i32 s55, s3, 28
  s_add_u32 s55, s55, s44
  s_lshl_b32 s55, s55, 11
  s_add_u32 s55, s55, 2097152
  v_and_b32 v61, 31, v1
  v_lshlrev_b32 v9, 10, v61
  v_lshrrev_b32 v10, 5, v1
  v_lshlrev_b32 v10, 5, v10
  v_add_u32 v60, v9, v10
  s_lshl_b32 s58, s69, 1
  s_add_u32 s58, s58, s45
  s_lshl_b32 s59, s58, 15
  s_lshl_b32 s44, s68, 1
  s_add_u32 s44, s44, s46
  s_lshl_b32 s44, s44, 6
  s_add_u32 s59, s59, s44
  s_lshl_b32 s58, s58, 6
  v_lshlrev_b32 v61, 1, v61
  s_mov_b32 s40, s4
  s_and_b32 s41, s5, 0xffff
  s_mov_b32 s42, 2097152
  s_mov_b32 s43, 0x20000
  v_lshlrev_b32 v8, 4, v1
  s_xor_b32 s53, s3, 1
  s_mul_i32 s53, s53, 12288
  v_add_u32 v9, s53, v8
  s_xor_b32 s53, s3, 2
  s_mul_i32 s53, s53, 12288
  s_add_u32 s53, s53, 4096
  v_add_u32 v10, s53, v8
  s_xor_b32 s53, s3, 3
  s_mul_i32 s53, s53, 12288
  s_add_u32 s53, s53, 8192
  v_add_u32 v11, s53, v8
  s_mul_i32 s53, s3, 12288
  v_add_u32 v12, s53, v8
  s_mov_b32 s36, s16
  s_and_b32 s37, s17, 0xffff
  s_mov_b32 s38, 7340032
  s_mov_b32 s39, 0x20000
  s_sub_u32 s57, s65, 4
  s_lshl_b32 s57, s57, 2
  s_add_u32 s57, s57, s3
  s_lshl_b32 s57, s57, 16
  s_lshl_b32 s53, s64, 9
  s_add_u32 s57, s57, s53
  v_lshrrev_b32 v2, 5, v1
  v_lshlrev_b32 v2, 12, v2
  v_and_b32 v3, 31, v1
  v_lshlrev_b32 v3, 4, v3
  v_add_u32 v2, v2, v3
  s_waitcnt vmcnt(19)
  v_mfma_f32_32x32x16_bf16 v[64:79], a[0:3], v[128:131], 0
  v_mfma_f32_32x32x16_bf16 v[96:111], a[4:7], v[128:131], 0
  buffer_load_dwordx4 v[128:131], v4, s[28:31], s52 offen sc1
  s_waitcnt vmcnt(19)
  v_mfma_f32_32x32x16_bf16 v[80:95], a[0:3], v[132:135], 0
  v_mfma_f32_32x32x16_bf16 v[112:127], a[4:7], v[132:135], 0
  buffer_load_dwordx4 v[132:135], v7, s[28:31], s52 offen sc1
  s_add_u32 s52, s52, 2048
  s_waitcnt vmcnt(19)
  v_mfma_f32_32x32x16_bf16 v[64:79], a[8:11], v[136:139], v[64:79]
  v_mfma_f32_32x32x16_bf16 v[96:111], a[12:15], v[136:139], v[96:111]
  buffer_load_dwordx4 v[136:139], v4, s[28:31], s52 offen sc1
  s_waitcnt vmcnt(19)
  v_mfma_f32_32x32x16_bf16 v[80:95], a[8:11], v[140:143], v[80:95]
  v_mfma_f32_32x32x16_bf16 v[112:127], a[12:15], v[140:143], v[112:127]
  buffer_load_dwordx4 v[140:143], v7, s[28:31], s52 offen sc1
  s_add_u32 s52, s52, 2048
  s_waitcnt vmcnt(19)
  v_mfma_f32_32x32x16_bf16 v[64:79], a[16:19], v[144:147], v[64:79]
  v_mfma_f32_32x32x16_bf16 v[96:111], a[20:23], v[144:147], v[96:111]
  buffer_load_dwordx4 v[144:147], v4, s[28:31], s52 offen sc1
  s_waitcnt vmcnt(19)
  v_mfma_f32_32x32x16_bf16 v[80:95], a[16:19], v[148:151], v[80:95]
  v_mfma_f32_32x32x16_bf16 v[112:127], a[20:23], v[148:151], v[112:127]
  buffer_load_dwordx4 v[148:151], v7, s[28:31], s52 offen sc1
  s_add_u32 s52, s52, 2048
  s_waitcnt vmcnt(19)
  v_mfma_f32_32x32x16_bf16 v[64:79], a[24:27], v[152:155], v[64:79]
  v_mfma_f32_32x32x16_bf16 v[96:111], a[28:31], v[152:155], v[96:111]
  buffer_load_dwordx4 v[152:155], v4, s[28:31], s52 offen sc1
  s_waitcnt vmcnt(19)
  v_mfma_f32_32x32x16_bf16 v[80:95], a[24:27], v[156:159], v[80:95]
  v_mfma_f32_32x32x16_bf16 v[112:127], a[28:31], v[156:159], v[112:127]
  buffer_load_dwordx4 v[156:159], v7, s[28:31], s52 offen sc1
  s_add_u32 s52, s52, 2048
  s_waitcnt vmcnt(19)
  v_mfma_f32_32x32x16_bf16 v[64:79], a[32:35], v[160:163], v[64:79]
  v_mfma_f32_32x32x16_bf16 v[96:111], a[36:39], v[160:163], v[96:111]
  buffer_load_dwordx4 v[160:163], v4, s[28:31], s52 offen sc1
  s_waitcnt vmcnt(19)
  v_mfma_f32_32x32x16_bf16 v[80:95], a[32:35], v[164:167], v[80:95]
  v_mfma_f32_32x32x16_bf16 v[112:127], a[36:39], v[164:167], v[112:127]
  buffer_load_dwordx4 v[164:167], v7, s[28:31], s52 offen sc1
  s_add_u32 s52, s52, 2048
  s_waitcnt vmcnt(19)
  v_mfma_f32_32x32x16_bf16 v[64:79], a[40:43], v[168:171], v[64:79]
  v_mfma_f32_32x32x16_bf16 v[96:111], a[44:47], v[168:171], v[96:111]
  buffer_load_dwordx4 v[168:171], v4, s[28:31], s52 offen sc1
  s_waitcnt vmcnt(19)
  v_mfma_f32_32x32x16_bf16 v[80:95], a[40:43], v[172:175], v[80:95]
  v_mfma_f32_32x32x16_bf16 v[112:127], a[44:47], v[172:175], v[112:127]
  buffer_load_dwordx4 v[172:175], v7, s[28:31], s52 offen sc1
  s_add_u32 s52, s52, 2048
  s_waitcnt vmcnt(19)
  v_mfma_f32_32x32x16_bf16 v[64:79], a[48:51], v[176:179], v[64:79]
  v_mfma_f32_32x32x16_bf16 v[96:111], a[52:55], v[176:179], v[96:111]
  buffer_load_dwordx4 v[176:179], v4, s[28:31], s52 offen sc1
  s_waitcnt vmcnt(19)
  v_mfma_f32_32x32x16_bf16 v[80:95], a[48:51], v[180:183], v[80:95]
  v_mfma_f32_32x32x16_bf16 v[112:127], a[52:55], v[180:183], v[112:127]
  buffer_load_dwordx4 v[180:183], v7, s[28:31], s52 offen sc1
  s_add_u32 s52, s52, 2048
  s_waitcnt vmcnt(19)
  v_mfma_f32_32x32x16_bf16 v[64:79], a[56:59], v[184:187], v[64:79]
  v_mfma_f32_32x32x16_bf16 v[96:111], a[60:63], v[184:187], v[96:111]
  buffer_load_dwordx4 v[184:187], v4, s[28:31], s52 offen sc1
  s_waitcnt vmcnt(19)
  v_mfma_f32_32x32x16_bf16 v[80:95], a[56:59], v[188:191], v[80:95]
  v_mfma_f32_32x32x16_bf16 v[112:127], a[60:63], v[188:191], v[112:127]
  buffer_load_dwordx4 v[188:191], v7, s[28:31], s52 offen sc1
  s_add_u32 s52, s52, 2048
  s_waitcnt vmcnt(15)
  v_mfma_f32_32x32x16_bf16 v[64:79], a[64:67], v[128:131], v[64:79]
  v_mfma_f32_32x32x16_bf16 v[96:111], a[68:71], v[128:131], v[96:111]
  buffer_load_dwordx4 v[128:131], v4, s[28:31], s52 offen sc1
  s_waitcnt vmcnt(15)
  v_mfma_f32_32x32x16_bf16 v[80:95], a[64:67], v[132:135], v[80:95]
  v_mfma_f32_32x32x16_bf16 v[112:127], a[68:71], v[132:135], v[112:127]
  buffer_load_dwordx4 v[132:135], v7, s[28:31], s52 offen sc1
  s_add_u32 s52, s52, 2048
  s_waitcnt vmcnt(15)
  v_mfma_f32_32x32x16_bf16 v[64:79], a[72:75], v[136:139], v[64:79]
  v_mfma_f32_32x32x16_bf16 v[96:111], a[76:79], v[136:139], v[96:111]
  buffer_load_dwordx4 v[136:139], v4, s[28:31], s52 offen sc1
  s_waitcnt vmcnt(15)
  v_mfma_f32_32x32x16_bf16 v[80:95], a[72:75], v[140:143], v[80:95]
  v_mfma_f32_32x32x16_bf16 v[112:127], a[76:79], v[140:143], v[112:127]
  buffer_load_dwordx4 v[140:143], v7, s[28:31], s52 offen sc1
  s_add_u32 s52, s52, 2048
  s_waitcnt vmcnt(15)
  v_mfma_f32_32x32x16_bf16 v[64:79], a[80:83], v[144:147], v[64:79]
  v_mfma_f32_32x32x16_bf16 v[96:111], a[84:87], v[144:147], v[96:111]
  buffer_load_dwordx4 v[144:147], v4, s[28:31], s52 offen sc1
  s_waitcnt vmcnt(15)
  v_mfma_f32_32x32x16_bf16 v[80:95], a[80:83], v[148:151], v[80:95]
  v_mfma_f32_32x32x16_bf16 v[112:127], a[84:87], v[148:151], v[112:127]
  buffer_load_dwordx4 v[148:151], v7, s[28:31], s52 offen sc1
  s_add_u32 s52, s52, 2048
  s_waitcnt vmcnt(15)
  v_mfma_f32_32x32x16_bf16 v[64:79], a[88:91], v[152:155], v[64:79]
  v_mfma_f32_32x32x16_bf16 v[96:111], a[92:95], v[152:155], v[96:111]
  buffer_load_dwordx4 v[152:155], v4, s[28:31], s52 offen sc1
  s_waitcnt vmcnt(15)
  v_mfma_f32_32x32x16_bf16 v[80:95], a[88:91], v[156:159], v[80:95]
  v_mfma_f32_32x32x16_bf16 v[112:127], a[92:95], v[156:159], v[112:127]
  buffer_load_dwordx4 v[156:159], v7, s[28:31], s52 offen sc1
  s_add_u32 s52, s52, 2048
  s_waitcnt vmcnt(15)
  v_mfma_f32_32x32x16_bf16 v[64:79], a[96:99], v[160:163], v[64:79]
  v_mfma_f32_32x32x16_bf16 v[96:111], a[100:103], v[160:163], v[96:111]
  buffer_load_dwordx4 v[160:163], v4, s[28:31], s52 offen sc1
  s_waitcnt vmcnt(15)
  v_mfma_f32_32x32x16_bf16 v[80:95], a[96:99], v[164:167], v[80:95]
  v_mfma_f32_32x32x16_bf16 v[112:127], a[100:103], v[164:167], v[112:127]
  buffer_load_dwordx4 v[164:167], v7, s[28:31], s52 offen sc1
  s_add_u32 s52, s52, 2048
  s_waitcnt vmcnt(15)
  v_mfma_f32_32x32x16_bf16 v[64:79], a[104:107], v[168:171], v[64:79]
  v_mfma_f32_32x32x16_bf16 v[96:111], a[108:111], v[168:171], v[96:111]
  buffer_load_dwordx4 v[168:171], v4, s[28:31], s52 offen sc1
  s_waitcnt vmcnt(15)
  v_mfma_f32_32x32x16_bf16 v[80:95], a[104:107], v[172:175], v[80:95]
  v_mfma_f32_32x32x16_bf16 v[112:127], a[108:111], v[172:175], v[112:127]
  buffer_load_dwordx4 v[172:175], v7, s[28:31], s52 offen sc1
  s_add_u32 s52, s52, 2048
  s_waitcnt vmcnt(15)
  v_mfma_f32_32x32x16_bf16 v[64:79], a[112:115], v[176:179], v[64:79]
  v_mfma_f32_32x32x16_bf16 v[96:111], a[116:119], v[176:179], v[96:111]
  buffer_load_dwordx4 v[176:179], v4, s[28:31], s52 offen sc1
  s_waitcnt vmcnt(15)
  v_mfma_f32_32x32x16_bf16 v[80:95], a[112:115], v[180:183], v[80:95]
  v_mfma_f32_32x32x16_bf16 v[112:127], a[116:119], v[180:183], v[112:127]
  buffer_load_dwordx4 v[180:183], v7, s[28:31], s52 offen sc1
  s_add_u32 s52, s52, 2048
  s_waitcnt vmcnt(15)
  v_mfma_f32_32x32x16_bf16 v[64:79], a[120:123], v[184:187], v[64:79]
  v_mfma_f32_32x32x16_bf16 v[96:111], a[124:127], v[184:187], v[96:111]
  buffer_load_dwordx4 v[184:187], v4, s[28:31], s52 offen sc1
  s_waitcnt vmcnt(15)
  v_mfma_f32_32x32x16_bf16 v[80:95], a[120:123], v[188:191], v[80:95]
  v_mfma_f32_32x32x16_bf16 v[112:127], a[124:127], v[188:191], v[112:127]
  buffer_load_dwordx4 v[188:191], v7, s[28:31], s52 offen sc1
  s_add_u32 s52, s52, 2048
  s_waitcnt vmcnt(15)
  v_mfma_f32_32x32x16_bf16 v[64:79], a[128:131], v[128:131], v[64:79]
  v_mfma_f32_32x32x16_bf16 v[96:111], a[132:135], v[128:131], v[96:111]
  buffer_load_dwordx4 v[128:131], v4, s[28:31], s52 offen sc1
  s_waitcnt vmcnt(15)
  v_mfma_f32_32x32x16_bf16 v[80:95], a[128:131], v[132:135], v[80:95]
  v_mfma_f32_32x32x16_bf16 v[112:127], a[132:135], v[132:135], v[112:127]
  buffer_load_dwordx4 v[132:135], v7, s[28:31], s52 offen sc1
  s_add_u32 s52, s52, 2048
  s_waitcnt vmcnt(15)
  v_mfma_f32_32x32x16_bf16 v[64:79], a[136:139], v[136:139], v[64:79]
  v_mfma_f32_32x32x16_bf16 v[96:111], a[140:143], v[136:139], v[96:111]
  buffer_load_dwordx4 v[136:139], v4, s[28:31], s52 offen sc1
  s_waitcnt vmcnt(15)
  v_mfma_f32_32x32x16_bf16 v[80:95], a[136:139], v[140:143], v[80:95]
  v_mfma_f32_32x32x16_bf16 v[112:127], a[140:143], v[140:143], v[112:127]
  buffer_load_dwordx4 v[140:143], v7, s[28:31], s52 offen sc1
  s_add_u32 s52, s52, 2048
  s_waitcnt vmcnt(15)
  v_mfma_f32_32x32x16_bf16 v[64:79], a[144:147], v[144:147], v[64:79]
  v_mfma_f32_32x32x16_bf16 v[96:111], a[148:151], v[144:147], v[96:111]
  buffer_load_dwordx4 v[144:147], v4, s[28:31], s52 offen sc1
  s_waitcnt vmcnt(15)
  v_mfma_f32_32x32x16_bf16 v[80:95], a[144:147], v[148:151], v[80:95]
  v_mfma_f32_32x32x16_bf16 v[112:127], a[148:151], v[148:151], v[112:127]
  buffer_load_dwordx4 v[148:151], v7, s[28:31], s52 offen sc1
  s_add_u32 s52, s52, 2048
  s_waitcnt vmcnt(15)
  v_mfma_f32_32x32x16_bf16 v[64:79], a[152:155], v[152:155], v[64:79]
  v_mfma_f32_32x32x16_bf16 v[96:111], a[156:159], v[152:155], v[96:111]
  buffer_load_dwordx4 v[152:155], v4, s[28:31], s52 offen sc1
  s_waitcnt vmcnt(15)
  v_mfma_f32_32x32x16_bf16 v[80:95], a[152:155], v[156:159], v[80:95]
  v_mfma_f32_32x32x16_bf16 v[112:127], a[156:159], v[156:159], v[112:127]
  buffer_load_dwordx4 v[156:159], v7, s[28:31], s52 offen sc1
  s_add_u32 s52, s52, 2048
  s_waitcnt vmcnt(15)
  v_mfma_f32_32x32x16_bf16 v[64:79], a[160:163], v[160:163], v[64:79]
  v_mfma_f32_32x32x16_bf16 v[96:111], a[164:167], v[160:163], v[96:111]
  buffer_load_dwordx4 v[160:163], v4, s[28:31], s52 offen sc1
  s_waitcnt vmcnt(15)
  v_mfma_f32_32x32x16_bf16 v[80:95], a[160:163], v[164:167], v[80:95]
  v_mfma_f32_32x32x16_bf16 v[112:127], a[164:167], v[164:167], v[112:127]
  buffer_load_dwordx4 v[164:167], v7, s[28:31], s52 offen sc1
  s_add_u32 s52, s52, 2048
  s_waitcnt vmcnt(15)
  v_mfma_f32_32x32x16_bf16 v[64:79], a[168:171], v[168:171], v[64:79]
  v_mfma_f32_32x32x16_bf16 v[96:111], a[172:175], v[168:171], v[96:111]
  buffer_load_dwordx4 v[168:171], v4, s[28:31], s52 offen sc1
  s_waitcnt vmcnt(15)
  v_mfma_f32_32x32x16_bf16 v[80:95], a[168:171], v[172:175], v[80:95]
  v_mfma_f32_32x32x16_bf16 v[112:127], a[172:175], v[172:175], v[112:127]
  buffer_load_dwordx4 v[172:175], v7, s[28:31], s52 offen sc1
  s_add_u32 s52, s52, 2048
  s_waitcnt vmcnt(15)
  v_mfma_f32_32x32x16_bf16 v[64:79], a[176:179], v[176:179], v[64:79]
  v_mfma_f32_32x32x16_bf16 v[96:111], a[180:183], v[176:179], v[96:111]
  buffer_load_dwordx4 v[176:179], v4, s[28:31], s52 offen sc1
  s_waitcnt vmcnt(15)
  v_mfma_f32_32x32x16_bf16 v[80:95], a[176:179], v[180:183], v[80:95]
  v_mfma_f32_32x32x16_bf16 v[112:127], a[180:183], v[180:183], v[112:127]
  buffer_load_dwordx4 v[180:183], v7, s[28:31], s52 offen sc1
  s_add_u32 s52, s52, 2048
  s_waitcnt vmcnt(15)
  v_mfma_f32_32x32x16_bf16 v[64:79], a[184:187], v[184:187], v[64:79]
  v_mfma_f32_32x32x16_bf16 v[96:111], a[188:191], v[184:187], v[96:111]
  buffer_load_dwordx4 v[184:187], v4, s[28:31], s52 offen sc1
  s_waitcnt vmcnt(15)
  v_mfma_f32_32x32x16_bf16 v[80:95], a[184:187], v[188:191], v[80:95]
  v_mfma_f32_32x32x16_bf16 v[112:127], a[188:191], v[188:191], v[112:127]
  buffer_load_dwordx4 v[188:191], v7, s[28:31], s52 offen sc1
  s_add_u32 s52, s52, 2048
  s_waitcnt vmcnt(15)
  v_mfma_f32_32x32x16_bf16 v[64:79], a[192:195], v[128:131], v[64:79]
  v_mfma_f32_32x32x16_bf16 v[96:111], a[196:199], v[128:131], v[96:111]
  s_waitcnt vmcnt(14)
  v_mfma_f32_32x32x16_bf16 v[80:95], a[192:195], v[132:135], v[80:95]
  v_mfma_f32_32x32x16_bf16 v[112:127], a[196:199], v[132:135], v[112:127]
  buffer_load_dwordx4 v[192:195], v48, s[28:31], s97 offen sc1
  buffer_load_dwordx4 v[196:199], v49, s[28:31], s97 offen sc1
  s_add_u32 s97, s97, 2048
  buffer_load_dwordx4 v[200:203], v48, s[28:31], s97 offen sc1
  buffer_load_dwordx4 v[204:207], v49, s[28:31], s97 offen sc1
  s_add_u32 s97, s97, 2048
  buffer_load_dwordx4 v[208:211], v48, s[28:31], s97 offen sc1
  buffer_load_dwordx4 v[212:215], v49, s[28:31], s97 offen sc1
  s_waitcnt vmcnt(19)
  v_mfma_f32_32x32x16_bf16 v[64:79], a[200:203], v[136:139], v[64:79]
  v_mfma_f32_32x32x16_bf16 v[96:111], a[204:207], v[136:139], v[96:111]
  s_waitcnt vmcnt(18)
  v_mfma_f32_32x32x16_bf16 v[80:95], a[200:203], v[140:143], v[80:95]
  v_mfma_f32_32x32x16_bf16 v[112:127], a[204:207], v[140:143], v[112:127]
  s_add_u32 s97, s97, 2048
  buffer_load_dwordx4 v[216:219], v48, s[28:31], s97 offen sc1
  buffer_load_dwordx4 v[220:223], v49, s[28:31], s97 offen sc1
  s_add_u32 s97, s97, 2048
  buffer_load_dwordx4 v[224:227], v48, s[28:31], s97 offen sc1
  buffer_load_dwordx4 v[228:231], v49, s[28:31], s97 offen sc1
  s_add_u32 s97, s97, 2048
  buffer_load_dwordx4 v[232:235], v48, s[28:31], s97 offen sc1
  s_waitcnt vmcnt(22)
  v_mfma_f32_32x32x16_bf16 v[64:79], a[208:211], v[144:147], v[64:79]
  v_mfma_f32_32x32x16_bf16 v[96:111], a[212:215], v[144:147], v[96:111]
  s_waitcnt vmcnt(21)
  v_mfma_f32_32x32x16_bf16 v[80:95], a[208:211], v[148:151], v[80:95]
  v_mfma_f32_32x32x16_bf16 v[112:127], a[212:215], v[148:151], v[112:127]
  buffer_load_dwordx4 v[236:239], v49, s[28:31], s97 offen sc1
  s_add_u32 s97, s97, 2048
  buffer_load_dwordx4 v[240:243], v48, s[28:31], s97 offen sc1
  buffer_load_dwordx4 v[244:247], v49, s[28:31], s97 offen sc1
  s_add_u32 s97, s97, 2048
  buffer_load_dwordx4 v[248:251], v48, s[28:31], s97 offen sc1
  buffer_load_dwordx4 v[252:255], v49, s[28:31], s97 offen sc1
  s_add_u32 s97, s97, 2048
  s_waitcnt vmcnt(25)
  v_mfma_f32_32x32x16_bf16 v[64:79], a[216:219], v[152:155], v[64:79]
  v_mfma_f32_32x32x16_bf16 v[96:111], a[220:223], v[152:155], v[96:111]
  s_waitcnt vmcnt(24)
  v_mfma_f32_32x32x16_bf16 v[80:95], a[216:219], v[156:159], v[80:95]
  v_mfma_f32_32x32x16_bf16 v[112:127], a[220:223], v[156:159], v[112:127]
  buffer_load_dwordx4 v[50:53], v60, s[40:43], s59 offen
  buffer_load_dwordx4 v[54:57], v60, s[40:43], s59 offen offset:16
  s_mov_b32 s32, s18
  s_and_b32 s33, s19, 0xffff
  s_mov_b32 s34, 4096
  s_mov_b32 s35, 0x20000
  buffer_load_ushort v58, v61, s[32:35], s58 offen
  s_waitcnt vmcnt(26)
  v_mfma_f32_32x32x16_bf16 v[64:79], a[224:227], v[160:163], v[64:79]
  v_mfma_f32_32x32x16_bf16 v[96:111], a[228:231], v[160:163], v[96:111]
  s_waitcnt vmcnt(25)
  v_mfma_f32_32x32x16_bf16 v[80:95], a[224:227], v[164:167], v[80:95]
  v_mfma_f32_32x32x16_bf16 v[112:127], a[228:231], v[164:167], v[112:127]
  buffer_load_dwordx4 v[24:27], v2, s[36:39], s57 offen
  s_add_u32 s57, s57, 8192
  buffer_load_dwordx4 v[24:27], v2, s[36:39], s57 offen
  s_add_u32 s57, s57, 8192
  s_waitcnt vmcnt(26)
  v_mfma_f32_32x32x16_bf16 v[64:79], a[232:235], v[168:171], v[64:79]
  v_mfma_f32_32x32x16_bf16 v[96:111], a[236:239], v[168:171], v[96:111]
  s_waitcnt vmcnt(25)
  v_mfma_f32_32x32x16_bf16 v[80:95], a[232:235], v[172:175], v[80:95]
  v_mfma_f32_32x32x16_bf16 v[112:127], a[236:239], v[172:175], v[112:127]
  buffer_load_dwordx4 v[24:27], v2, s[36:39], s57 offen
  s_add_u32 s57, s57, 8192
  buffer_load_dwordx4 v[24:27], v2, s[36:39], s57 offen
  s_add_u32 s57, s57, 8192
  s_waitcnt vmcnt(26)
  v_mfma_f32_32x32x16_bf16 v[64:79], a[240:243], v[176:179], v[64:79]
  v_mfma_f32_32x32x16_bf16 v[96:111], a[244:247], v[176:179], v[96:111]
  s_waitcnt vmcnt(25)
  v_mfma_f32_32x32x16_bf16 v[80:95], a[240:243], v[180:183], v[80:95]
  v_mfma_f32_32x32x16_bf16 v[112:127], a[244:247], v[180:183], v[112:127]
  buffer_load_dwordx4 v[24:27], v2, s[36:39], s57 offen
  s_add_u32 s57, s57, 8192
  buffer_load_dwordx4 v[24:27], v2, s[36:39], s57 offen
  s_add_u32 s57, s57, 8192
  s_waitcnt vmcnt(26)
  v_mfma_f32_32x32x16_bf16 v[64:79], a[248:251], v[184:187], v[64:79]
  v_mfma_f32_32x32x16_bf16 v[96:111], a[252:255], v[184:187], v[96:111]
  s_waitcnt vmcnt(25)
  v_mfma_f32_32x32x16_bf16 v[80:95], a[248:251], v[188:191], v[80:95]
  v_mfma_f32_32x32x16_bf16 v[112:127], a[252:255], v[188:191], v[112:127]
  buffer_load_dwordx4 v[24:27], v2, s[36:39], s57 offen
  s_add_u32 s57, s57, 8192
  buffer_load_dwordx4 v[24:27], v2, s[36:39], s57 offen
  s_add_u32 s57, s57, 8192
  s_barrier
  s_nop 5
  ds_write_b128 v9, v[80:83] offset:0
  ds_write_b128 v9, v[84:87] offset:1024
  ds_write_b128 v9, v[88:91] offset:2048
  ds_write_b128 v9, v[92:95] offset:3072
  ds_write_b128 v10, v[96:99] offset:0
  ds_write_b128 v10, v[100:103] offset:1024
  ds_write_b128 v10, v[104:107] offset:2048
  ds_write_b128 v10, v[108:111] offset:3072
  ds_write_b128 v11, v[112:115] offset:0
  ds_write_b128 v11, v[116:119] offset:1024
  ds_write_b128 v11, v[120:123] offset:2048
  ds_write_b128 v11, v[124:127] offset:3072
  v_lshlrev_b32 v32, 16, v16
  v_and_b32 v33, 0xffff0000, v16
  v_lshlrev_b32 v34, 16, v17
  v_and_b32 v35, 0xffff0000, v17
  v_lshlrev_b32 v36, 16, v18
  v_and_b32 v37, 0xffff0000, v18
  v_lshlrev_b32 v38, 16, v19
  v_and_b32 v39, 0xffff0000, v19
  v_lshlrev_b32 v40, 16, v20
  v_and_b32 v41, 0xffff0000, v20
  v_lshlrev_b32 v42, 16, v21
  v_and_b32 v43, 0xffff0000, v21
  v_lshlrev_b32 v44, 16, v22
  v_and_b32 v45, 0xffff0000, v22
  v_lshlrev_b32 v46, 16, v23
  v_and_b32 v47, 0xffff0000, v23
  v_pk_add_f32 v[64:65], v[64:65], v[32:33]
  v_pk_add_f32 v[66:67], v[66:67], v[34:35]
  v_pk_add_f32 v[68:69], v[68:69], v[36:37]
  v_pk_add_f32 v[70:71], v[70:71], v[38:39]
  v_pk_add_f32 v[72:73], v[72:73], v[40:41]
  v_pk_add_f32 v[74:75], v[74:75], v[42:43]
  v_pk_add_f32 v[76:77], v[76:77], v[44:45]
  v_pk_add_f32 v[78:79], v[78:79], v[46:47]
  v_mov_b32 v14, 0xc0135761
  v_mov_b32 v15, 0xc0135761
  v_mov_b32 v16, 0xbdd2d3e8
  v_mov_b32 v17, 0xbdd2d3e8
  v_mov_b32 v18, 1.0
  v_mov_b32 v19, 1.0
  s_waitcnt lgkmcnt(0)
  s_barrier
  ds_read_b128 v[128:131], v12 offset:0
  ds_read_b128 v[132:135], v12 offset:1024
  ds_read_b128 v[136:139], v12 offset:2048
  ds_read_b128 v[140:143], v12 offset:3072
  ds_read_b128 v[144:147], v12 offset:4096
  ds_read_b128 v[148:151], v12 offset:5120
  ds_read_b128 v[152:155], v12 offset:6144
  ds_read_b128 v[156:159], v12 offset:7168
  ds_read_b128 v[160:163], v12 offset:8192
  ds_read_b128 v[164:167], v12 offset:9216
  ds_read_b128 v[168:171], v12 offset:10240
  ds_read_b128 v[172:175], v12 offset:11264
  s_waitcnt lgkmcnt(8)
  v_pk_add_f32 v[64:65], v[64:65], v[128:129]
  v_pk_add_f32 v[66:67], v[66:67], v[130:131]
  v_pk_add_f32 v[68:69], v[68:69], v[132:133]
  v_pk_add_f32 v[70:71], v[70:71], v[134:135]
  v_pk_add_f32 v[72:73], v[72:73], v[136:137]
  v_pk_add_f32 v[74:75], v[74:75], v[138:139]
  v_pk_add_f32 v[76:77], v[76:77], v[140:141]
  v_pk_add_f32 v[78:79], v[78:79], v[142:143]
  s_waitcnt lgkmcnt(4)
  v_pk_add_f32 v[64:65], v[64:65], v[144:145]
  v_pk_add_f32 v[66:67], v[66:67], v[146:147]
  v_pk_add_f32 v[68:69], v[68:69], v[148:149]
  v_pk_add_f32 v[70:71], v[70:71], v[150:151]
  v_pk_add_f32 v[72:73], v[72:73], v[152:153]
  v_pk_add_f32 v[74:75], v[74:75], v[154:155]
  v_pk_add_f32 v[76:77], v[76:77], v[156:157]
  v_pk_add_f32 v[78:79], v[78:79], v[158:159]
  s_waitcnt lgkmcnt(0)
  v_pk_add_f32 v[64:65], v[64:65], v[160:161]
  v_pk_add_f32 v[66:67], v[66:67], v[162:163]
  v_pk_add_f32 v[68:69], v[68:69], v[164:165]
  v_pk_add_f32 v[70:71], v[70:71], v[166:167]
  v_pk_add_f32 v[72:73], v[72:73], v[168:169]
  v_pk_add_f32 v[74:75], v[74:75], v[170:171]
  v_pk_add_f32 v[76:77], v[76:77], v[172:173]
  v_pk_add_f32 v[78:79], v[78:79], v[174:175]
  v_pk_mul_f32 v[128:129], v[64:65], v[64:65]
  v_pk_mul_f32 v[130:131], v[66:67], v[66:67]
  v_pk_mul_f32 v[132:133], v[68:69], v[68:69]
  v_pk_mul_f32 v[134:135], v[70:71], v[70:71]
  v_pk_mul_f32 v[136:137], v[72:73], v[72:73]
  v_pk_mul_f32 v[138:139], v[74:75], v[74:75]
  v_pk_mul_f32 v[140:141], v[76:77], v[76:77]
  v_pk_mul_f32 v[142:143], v[78:79], v[78:79]
  v_pk_fma_f32 v[128:129], v[128:129], v[16:17], v[14:15]
  v_pk_fma_f32 v[130:131], v[130:131], v[16:17], v[14:15]
  v_pk_fma_f32 v[132:133], v[132:133], v[16:17], v[14:15]
  v_pk_fma_f32 v[134:135], v[134:135], v[16:17], v[14:15]
  v_pk_fma_f32 v[136:137], v[136:137], v[16:17], v[14:15]
  v_pk_fma_f32 v[138:139], v[138:139], v[16:17], v[14:15]
  v_pk_fma_f32 v[140:141], v[140:141], v[16:17], v[14:15]
  v_pk_fma_f32 v[142:143], v[142:143], v[16:17], v[14:15]
  v_pk_mul_f32 v[128:129], v[128:129], v[64:65]
  v_pk_mul_f32 v[130:131], v[130:131], v[66:67]
  v_pk_mul_f32 v[132:133], v[132:133], v[68:69]
  v_pk_mul_f32 v[134:135], v[134:135], v[70:71]
  v_pk_mul_f32 v[136:137], v[136:137], v[72:73]
  v_pk_mul_f32 v[138:139], v[138:139], v[74:75]
  v_pk_mul_f32 v[140:141], v[140:141], v[76:77]
  v_pk_mul_f32 v[142:143], v[142:143], v[78:79]
  v_exp_f32 v128, v128
  v_exp_f32 v129, v129
  v_exp_f32 v130, v130
  v_exp_f32 v131, v131
  v_exp_f32 v132, v132
  v_exp_f32 v133, v133
  v_exp_f32 v134, v134
  v_exp_f32 v135, v135
  v_exp_f32 v136, v136
  v_exp_f32 v137, v137
  v_exp_f32 v138, v138
  v_exp_f32 v139, v139
  v_exp_f32 v140, v140
  v_exp_f32 v141, v141
  v_exp_f32 v142, v142
  v_exp_f32 v143, v143
  v_pk_add_f32 v[128:129], v[128:129], v[18:19]
  v_pk_add_f32 v[130:131], v[130:131], v[18:19]
  v_pk_add_f32 v[132:133], v[132:133], v[18:19]
  v_pk_add_f32 v[134:135], v[134:135], v[18:19]
  v_pk_add_f32 v[136:137], v[136:137], v[18:19]
  v_pk_add_f32 v[138:139], v[138:139], v[18:19]
  v_pk_add_f32 v[140:141], v[140:141], v[18:19]
  v_pk_add_f32 v[142:143], v[142:143], v[18:19]
  v_rcp_f32 v128, v128
  v_rcp_f32 v129, v129
  v_rcp_f32 v130, v130
  v_rcp_f32 v131, v131
  v_rcp_f32 v132, v132
  v_rcp_f32 v133, v133
  v_rcp_f32 v134, v134
  v_rcp_f32 v135, v135
  v_rcp_f32 v136, v136
  v_rcp_f32 v137, v137
  v_rcp_f32 v138, v138
  v_rcp_f32 v139, v139
  v_rcp_f32 v140, v140
  v_rcp_f32 v141, v141
  v_rcp_f32 v142, v142
  v_rcp_f32 v143, v143
  v_pk_mul_f32 v[128:129], v[128:129], v[64:65]
  v_pk_mul_f32 v[130:131], v[130:131], v[66:67]
  v_pk_mul_f32 v[132:133], v[132:133], v[68:69]
  v_pk_mul_f32 v[134:135], v[134:135], v[70:71]
  v_pk_mul_f32 v[136:137], v[136:137], v[72:73]
  v_pk_mul_f32 v[138:139], v[138:139], v[74:75]
  v_pk_mul_f32 v[140:141], v[140:141], v[76:77]
  v_pk_mul_f32 v[142:143], v[142:143], v[78:79]
  v_cvt_pk_bf16_f32 v144, v128, v129
  v_cvt_pk_bf16_f32 v145, v130, v131
  v_cvt_pk_bf16_f32 v146, v132, v133
  v_cvt_pk_bf16_f32 v147, v134, v135
  v_cvt_pk_bf16_f32 v148, v136, v137
  v_cvt_pk_bf16_f32 v149, v138, v139
  v_cvt_pk_bf16_f32 v150, v140, v141
  v_cvt_pk_bf16_f32 v151, v142, v143
  s_mul_i32 s53, s66, 144
  s_lshl_b32 s54, s67, 2
  s_add_u32 s53, s53, s54
  s_lshl_b32 s54, s47, 1
  s_add_u32 s53, s53, s54
  s_lshl_b32 s53, s53, 1
  s_add_u32 s53, s53, s48
  s_lshl_b32 s53, s53, 10
  s_add_u32 s53, s53, 2097152
  v_lshlrev_b32 v8, 4, v1
  buffer_store_dwordx4 v[144:147], v8, s[28:31], s53 offen sc1
  buffer_store_dwordx4 v[148:151], v8, s[28:31], s53 offen offset:2048 sc1
  s_lshl_b32 s100, s66, 2
  s_lshr_b32 s53, s64, 1
  s_add_u32 s100, s100, s53
  s_lshl_b32 s100, s100, 7
  s_add_u32 s100, s100, 12587008
  s_waitcnt vmcnt(0)
  s_barrier
  s_cmp_lg_u32 s3, 0
  s_cbranch_scc1 fz_sg_skip
  v_mov_b32 v44, 0
  v_mov_b32 v45, 1
  s_mov_b64 exec, 1
  buffer_atomic_add v45, v44, s[28:31], s100 offen sc1
  s_mov_b64 exec, -1
fz_sg_skip:
  s_add_u32 m0, s98, 0
  s_nop 0
  buffer_load_dwordx4 v28, s[24:27], s99 offen  lds
  buffer_load_dwordx4 v29, s[24:27], s99 offen offset:1024  lds
  s_add_u32 s99, s99, 65536
  s_add_u32 m0, s98, 2048
  s_nop 0
  buffer_load_dwordx4 v28, s[24:27], s99 offen  lds
  buffer_load_dwordx4 v29, s[24:27], s99 offen offset:1024  lds
  s_add_u32 s99, s99, 65536
  s_add_u32 m0, s98, 4096
  s_nop 0
  buffer_load_dwordx4 v28, s[24:27], s99 offen  lds
  buffer_load_dwordx4 v29, s[24:27], s99 offen offset:1024  lds
  s_add_u32 s99, s99, 65536
  s_add_u32 m0, s98, 6144
  s_nop 0
  buffer_load_dwordx4 v28, s[24:27], s99 offen  lds
  buffer_load_dwordx4 v29, s[24:27], s99 offen offset:1024  lds
  s_add_u32 s99, s99, 65536
  s_add_u32 m0, s98, 8192
  s_nop 0
  buffer_load_dwordx4 v28, s[24:27], s99 offen  lds
  buffer_load_dwordx4 v29, s[24:27], s99 offen offset:1024  lds
  s_add_u32 s99, s99, 65536
  s_add_u32 m0, s98, 10240
  s_nop 0
  buffer_load_dwordx4 v28, s[24:27], s99 offen  lds
  buffer_load_dwordx4 v29, s[24:27], s99 offen offset:1024  lds
  s_add_u32 s99, s99, 65536
  s_add_u32 m0, s98, 12288
  s_nop 0
  buffer_load_dwordx4 v28, s[24:27], s99 offen  lds
  buffer_load_dwordx4 v29, s[24:27], s99 offen offset:1024  lds
  s_add_u32 s99, s99, 65536
  s_add_u32 m0, s98, 14336
  s_nop 0
  buffer_load_dwordx4 v28, s[24:27], s99 offen  lds
  buffer_load_dwordx4 v29, s[24:27], s99 offen offset:1024  lds
  s_add_u32 s99, s99, 65536
  s_add_u32 m0, s98, 16384
  s_nop 0
  buffer_load_dwordx4 v28, s[24:27], s99 offen  lds
  buffer_load_dwordx4 v29, s[24:27], s99 offen offset:1024  lds
  s_add_u32 s99, s99, 65536
  s_add_u32 m0, s98, 18432
  s_nop 0
  buffer_load_dwordx4 v28, s[24:27], s99 offen  lds
  buffer_load_dwordx4 v29, s[24:27], s99 offen offset:1024  lds
  s_add_u32 s99, s99, 65536
  s_add_u32 m0, s98, 20480
  s_nop 0
  buffer_load_dwordx4 v28, s[24:27], s99 offen  lds
  buffer_load_dwordx4 v29, s[24:27], s99 offen offset:1024  lds
  s_add_u32 s99, s99, 65536
  s_add_u32 m0, s98, 22528
  s_nop 0
  buffer_load_dwordx4 v28, s[24:27], s99 offen  lds
  buffer_load_dwordx4 v29, s[24:27], s99 offen offset:1024  lds
  s_add_u32 s99, s99, 65536
  s_add_u32 m0, s98, 24576
  s_nop 0
  buffer_load_dwordx4 v28, s[24:27], s99 offen  lds
  buffer_load_dwordx4 v29, s[24:27], s99 offen offset:1024  lds
  s_add_u32 s99, s99, 65536
  s_add_u32 m0, s98, 26624
  s_nop 0
  buffer_load_dwordx4 v28, s[24:27], s99 offen  lds
  buffer_load_dwordx4 v29, s[24:27], s99 offen offset:1024  lds
  s_add_u32 s99, s99, 65536
  s_waitcnt vmcnt(0)
  s_lshl_b32 s74, s68, 9
  s_add_u32 s74, s74, 12587008
  v_lshlrev_b32 v32, 7, v1
  v_mov_b32 v33, 7
  s_mov_b32 exec_lo, 0xf
  s_mov_b32 exec_hi, 0
  buffer_load_dword v34, v32, s[28:31], s74 offen sc1
  s_mov_b64 exec, -1
  ds_read_b64_tr_b16 a[0:1], v30 offset:0
  ds_read_b64_tr_b16 a[2:3], v30 offset:1024
  ds_read_b64_tr_b16 a[4:5], v31 offset:0
  ds_read_b64_tr_b16 a[6:7], v31 offset:1024
  ds_read_b64_tr_b16 a[8:9], v30 offset:2048
  ds_read_b64_tr_b16 a[10:11], v30 offset:3072
  ds_read_b64_tr_b16 a[12:13], v31 offset:2048
  ds_read_b64_tr_b16 a[14:15], v31 offset:3072
  s_waitcnt lgkmcnt(4)
  s_add_u32 m0, s98, 0
  s_nop 0
  buffer_load_dwordx4 v28, s[24:27], s99 offen  lds
  buffer_load_dwordx4 v29, s[24:27], s99 offen offset:1024  lds
  s_add_u32 s99, s99, 65536
  ds_read_b64_tr_b16 a[16:17], v30 offset:4096
  ds_read_b64_tr_b16 a[18:19], v30 offset:5120
  ds_read_b64_tr_b16 a[20:21], v31 offset:4096
  ds_read_b64_tr_b16 a[22:23], v31 offset:5120
  s_waitcnt lgkmcnt(4)
  s_add_u32 m0, s98, 2048
  s_nop 0
  buffer_load_dwordx4 v28, s[24:27], s99 offen  lds
  buffer_load_dwordx4 v29, s[24:27], s99 offen offset:1024  lds
  s_add_u32 s99, s99, 65536
  ds_read_b64_tr_b16 a[24:25], v30 offset:6144
  ds_read_b64_tr_b16 a[26:27], v30 offset:7168
  ds_read_b64_tr_b16 a[28:29], v31 offset:6144
  ds_read_b64_tr_b16 a[30:31], v31 offset:7168
  s_waitcnt lgkmcnt(4)
  s_add_u32 m0, s98, 4096
  s_nop 0
  buffer_load_dwordx4 v28, s[24:27], s99 offen  lds
  buffer_load_dwordx4 v29, s[24:27], s99 offen offset:1024  lds
  s_add_u32 s99, s99, 65536
  ds_read_b64_tr_b16 a[32:33], v30 offset:8192
  ds_read_b64_tr_b16 a[34:35], v30 offset:9216
  ds_read_b64_tr_b16 a[36:37], v31 offset:8192
  ds_read_b64_tr_b16 a[38:39], v31 offset:9216
  s_waitcnt lgkmcnt(4)
  s_add_u32 m0, s98, 6144
  s_nop 0
  buffer_load_dwordx4 v28, s[24:27], s99 offen  lds
  buffer_load_dwordx4 v29, s[24:27], s99 offen offset:1024  lds
  s_add_u32 s99, s99, 65536
  ds_read_b64_tr_b16 a[40:41], v30 offset:10240
  ds_read_b64_tr_b16 a[42:43], v30 offset:11264
  ds_read_b64_tr_b16 a[44:45], v31 offset:10240
  ds_read_b64_tr_b16 a[46:47], v31 offset:11264
  s_waitcnt lgkmcnt(4)
  s_add_u32 m0, s98, 8192
  s_nop 0
  buffer_load_dwordx4 v28, s[24:27], s99 offen  lds
  buffer_load_dwordx4 v29, s[24:27], s99 offen offset:1024  lds
  s_add_u32 s99, s99, 65536
  ds_read_b64_tr_b16 a[48:49], v30 offset:12288
  ds_read_b64_tr_b16 a[50:51], v30 offset:13312
  ds_read_b64_tr_b16 a[52:53], v31 offset:12288
  ds_read_b64_tr_b16 a[54:55], v31 offset:13312
  s_waitcnt lgkmcnt(4)
  s_add_u32 m0, s98, 10240
  s_nop 0
  buffer_load_dwordx4 v28, s[24:27], s99 offen  lds
  buffer_load_dwordx4 v29, s[24:27], s99 offen offset:1024  lds
  s_add_u32 s99, s99, 65536
  ds_read_b64_tr_b16 a[56:57], v30 offset:14336
  ds_read_b64_tr_b16 a[58:59], v30 offset:15360
  ds_read_b64_tr_b16 a[60:61], v31 offset:14336
  ds_read_b64_tr_b16 a[62:63], v31 offset:15360
  s_waitcnt lgkmcnt(4)
  s_add_u32 m0, s98, 12288
  s_nop 0
  buffer_load_dwordx4 v28, s[24:27], s99 offen  lds
  buffer_load_dwordx4 v29, s[24:27], s99 offen offset:1024  lds
  s_add_u32 s99, s99, 65536
  ds_read_b64_tr_b16 a[64:65], v30 offset:16384
  ds_read_b64_tr_b16 a[66:67], v30 offset:17408
  ds_read_b64_tr_b16 a[68:69], v31 offset:16384
  ds_read_b64_tr_b16 a[70:71], v31 offset:17408
  s_waitcnt lgkmcnt(4)
  s_add_u32 m0, s98, 14336
  s_nop 0
  buffer_load_dwordx4 v28, s[24:27], s99 offen  lds
  buffer_load_dwordx4 v29, s[24:27], s99 offen offset:1024  lds
  s_add_u32 s99, s99, 65536
  ds_read_b64_tr_b16 a[72:73], v30 offset:18432
  ds_read_b64_tr_b16 a[74:75], v30 offset:19456
  ds_read_b64_tr_b16 a[76:77], v31 offset:18432
  ds_read_b64_tr_b16 a[78:79], v31 offset:19456
  s_waitcnt lgkmcnt(4)
  s_add_u32 m0, s98, 16384
  s_nop 0
  buffer_load_dwordx4 v28, s[24:27], s99 offen  lds
  buffer_load_dwordx4 v29, s[24:27], s99 offen offset:1024  lds
  s_add_u32 s99, s99, 65536
  ds_read_b64_tr_b16 a[80:81], v30 offset:20480
  ds_read_b64_tr_b16 a[82:83], v30 offset:21504
  ds_read_b64_tr_b16 a[84:85], v31 offset:20480
  ds_read_b64_tr_b16 a[86:87], v31 offset:21504
  s_waitcnt lgkmcnt(4)
  s_add_u32 m0, s98, 18432
  s_nop 0
  buffer_load_dwordx4 v28, s[24:27], s99 offen  lds
  buffer_load_dwordx4 v29, s[24:27], s99 offen offset:1024  lds
  s_add_u32 s99, s99, 65536
  ds_read_b64_tr_b16 a[88:89], v30 offset:22528
  ds_read_b64_tr_b16 a[90:91], v30 offset:23552
  ds_read_b64_tr_b16 a[92:93], v31 offset:22528
  ds_read_b64_tr_b16 a[94:95], v31 offset:23552
  s_waitcnt lgkmcnt(4)
  s_add_u32 m0, s98, 20480
  s_nop 0
  buffer_load_dwordx4 v28, s[24:27], s99 offen  lds
  buffer_load_dwordx4 v29, s[24:27], s99 offen offset:1024  lds
  s_add_u32 s99, s99, 65536
  ds_read_b64_tr_b16 a[96:97], v30 offset:24576
  ds_read_b64_tr_b16 a[98:99], v30 offset:25600
  ds_read_b64_tr_b16 a[100:101], v31 offset:24576
  ds_read_b64_tr_b16 a[102:103], v31 offset:25600
  s_waitcnt lgkmcnt(4)
  s_add_u32 m0, s98, 22528
  s_nop 0
  buffer_load_dwordx4 v28, s[24:27], s99 offen  lds
  buffer_load_dwordx4 v29, s[24:27], s99 offen offset:1024  lds
  s_add_u32 s99, s99, 65536
  ds_read_b64_tr_b16 a[104:105], v30 offset:26624
  ds_read_b64_tr_b16 a[106:107], v30 offset:27648
  ds_read_b64_tr_b16 a[108:109], v31 offset:26624
  ds_read_b64_tr_b16 a[110:111], v31 offset:27648
  s_waitcnt lgkmcnt(4)
  s_add_u32 m0, s98, 24576
  s_nop 0
  buffer_load_dwordx4 v28, s[24:27], s99 offen  lds
  buffer_load_dwordx4 v29, s[24:27], s99 offen offset:1024  lds
  s_add_u32 s99, s99, 65536
  s_waitcnt lgkmcnt(0)
  s_add_u32 m0, s98, 26624
  s_nop 0
  buffer_load_dwordx4 v28, s[24:27], s99 offen  lds
  buffer_load_dwordx4 v29, s[24:27], s99 offen offset:1024  lds
  s_add_u32 s99, s99, 65536
  v_lshlrev_b32 v8, 4, v1
  s_xor_b32 s53, s3, 1
  s_mul_i32 s53, s53, 12288
  v_add_u32 v9, s53, v8
  s_xor_b32 s53, s3, 2
  s_mul_i32 s53, s53, 12288
  s_add_u32 s53, s53, 4096
  v_add_u32 v10, s53, v8
  s_xor_b32 s53, s3, 3
  s_mul_i32 s53, s53, 12288
  s_add_u32 s53, s53, 8192
  v_add_u32 v11, s53, v8
  s_mul_i32 s53, s3, 12288
  v_add_u32 v12, s53, v8
  s_mov_b32 s73, 0
  s_waitcnt vmcnt(28)
  v_mov_b32 v35, v34
  s_mov_b32 exec_lo, 0xf
  s_mov_b32 exec_hi, 0
fzg_gc_l:
  v_cmp_ge_u32 vcc, v35, v33
  s_nop 2
  s_cmp_eq_u64 vcc, exec
  s_cbranch_scc1 fzg_gc_d
  buffer_load_dword v35, v32, s[28:31], s74 offen sc1
  s_add_u32 s73, s73, 1
  s_waitcnt vmcnt(0)
  s_cmp_lt_u32 s73, 131072
  s_cbranch_scc1 fzg_gc_l
fzg_gc_d:
  s_mov_b64 exec, -1
  buffer_load_dwordx4 v[128:131], v48, s[28:31], s55 offen sc1
  buffer_load_dwordx4 v[132:135], v49, s[28:31], s55 offen sc1
  s_add_u32 s55, s55, 2048
  buffer_load_dwordx4 v[136:139], v48, s[28:31], s55 offen sc1
  buffer_load_dwordx4 v[140:143], v49, s[28:31], s55 offen sc1
  s_add_u32 s55, s55, 2048
  buffer_load_dwordx4 v[144:147], v48, s[28:31], s55 offen sc1
  buffer_load_dwordx4 v[148:151], v49, s[28:31], s55 offen sc1
  s_add_u32 s55, s55, 2048
  buffer_load_dwordx4 v[152:155], v48, s[28:31], s55 offen sc1
  buffer_load_dwordx4 v[156:159], v49, s[28:31], s55 offen sc1
  s_add_u32 s55, s55, 2048
  buffer_load_dwordx4 v[160:163], v48, s[28:31], s55 offen sc1
  buffer_load_dwordx4 v[164:167], v49, s[28:31], s55 offen sc1
  s_add_u32 s55, s55, 2048
  buffer_load_dwordx4 v[168:171], v48, s[28:31], s55 offen sc1
  buffer_load_dwordx4 v[172:175], v49, s[28:31], s55 offen sc1
  s_add_u32 s55, s55, 2048
  buffer_load_dwordx4 v[176:179], v48, s[28:31], s55 offen sc1
  buffer_load_dwordx4 v[180:183], v49, s[28:31], s55 offen sc1
  s_add_u32 s55, s55, 2048
  buffer_load_dwordx4 v[184:187], v48, s[28:31], s55 offen sc1
  buffer_load_dwordx4 v[188:191], v49, s[28:31], s55 offen sc1
  s_add_u32 s55, s55, 2048
  s_waitcnt vmcnt(15)
  v_mfma_f32_32x32x16_bf16 v[64:79], v[128:131], a[0:3], 0
  v_mfma_f32_32x32x16_bf16 v[80:95], v[128:131], a[4:7], 0
  buffer_load_dwordx4 v[128:131], v48, s[28:31], s55 offen sc1
  s_waitcnt vmcnt(15)
  v_mfma_f32_32x32x16_bf16 v[96:111], v[132:135], a[0:3], 0
  v_mfma_f32_32x32x16_bf16 v[112:127], v[132:135], a[4:7], 0
  buffer_load_dwordx4 v[132:135], v49, s[28:31], s55 offen sc1
  s_add_u32 s55, s55, 2048
  s_waitcnt vmcnt(15)
  v_mfma_f32_32x32x16_bf16 v[64:79], v[136:139], a[8:11], v[64:79]
  v_mfma_f32_32x32x16_bf16 v[80:95], v[136:139], a[12:15], v[80:95]
  buffer_load_dwordx4 v[136:139], v48, s[28:31], s55 offen sc1
  s_waitcnt vmcnt(15)
  v_mfma_f32_32x32x16_bf16 v[96:111], v[140:143], a[8:11], v[96:111]
  v_mfma_f32_32x32x16_bf16 v[112:127], v[140:143], a[12:15], v[112:127]
  buffer_load_dwordx4 v[140:143], v49, s[28:31], s55 offen sc1
  s_add_u32 s55, s55, 2048
  s_waitcnt vmcnt(15)
  v_mfma_f32_32x32x16_bf16 v[64:79], v[144:147], a[16:19], v[64:79]
  v_mfma_f32_32x32x16_bf16 v[80:95], v[144:147], a[20:23], v[80:95]
  buffer_load_dwordx4 v[144:147], v48, s[28:31], s55 offen sc1
  s_waitcnt vmcnt(15)
  v_mfma_f32_32x32x16_bf16 v[96:111], v[148:151], a[16:19], v[96:111]
  v_mfma_f32_32x32x16_bf16 v[112:127], v[148:151], a[20:23], v[112:127]
  buffer_load_dwordx4 v[148:151], v49, s[28:31], s55 offen sc1
  s_add_u32 s55, s55, 2048
  s_waitcnt vmcnt(15)
  v_mfma_f32_32x32x16_bf16 v[64:79], v[152:155], a[24:27], v[64:79]
  v_mfma_f32_32x32x16_bf16 v[80:95], v[152:155], a[28:31], v[80:95]
  buffer_load_dwordx4 v[152:155], v48, s[28:31], s55 offen sc1
  s_waitcnt vmcnt(15)
  v_mfma_f32_32x32x16_bf16 v[96:111], v[156:159], a[24:27], v[96:111]
  v_mfma_f32_32x32x16_bf16 v[112:127], v[156:159], a[28:31], v[112:127]
  buffer_load_dwordx4 v[156:159], v49, s[28:31], s55 offen sc1
  s_add_u32 s55, s55, 2048
  s_waitcnt vmcnt(15)
  v_mfma_f32_32x32x16_bf16 v[64:79], v[160:163], a[32:35], v[64:79]
  v_mfma_f32_32x32x16_bf16 v[80:95], v[160:163], a[36:39], v[80:95]
  buffer_load_dwordx4 v[160:163], v48, s[28:31], s55 offen sc1
  s_waitcnt vmcnt(15)
  v_mfma_f32_32x32x16_bf16 v[96:111], v[164:167], a[32:35], v[96:111]
  v_mfma_f32_32x32x16_bf16 v[112:127], v[164:167], a[36:39], v[112:127]
  buffer_load_dwordx4 v[164:167], v49, s[28:31], s55 offen sc1
  s_add_u32 s55, s55, 2048
  s_waitcnt vmcnt(15)
  v_mfma_f32_32x32x16_bf16 v[64:79], v[168:171], a[40:43], v[64:79]
  v_mfma_f32_32x32x16_bf16 v[80:95], v[168:171], a[44:47], v[80:95]
  buffer_load_dwordx4 v[168:171], v48, s[28:31], s55 offen sc1
  s_waitcnt vmcnt(15)
  v_mfma_f32_32x32x16_bf16 v[96:111], v[172:175], a[40:43], v[96:111]
  v_mfma_f32_32x32x16_bf16 v[112:127], v[172:175], a[44:47], v[112:127]
  buffer_load_dwordx4 v[172:175], v49, s[28:31], s55 offen sc1
  s_add_u32 s55, s55, 2048
  s_waitcnt vmcnt(15)
  v_mfma_f32_32x32x16_bf16 v[64:79], v[176:179], a[48:51], v[64:79]
  v_mfma_f32_32x32x16_bf16 v[80:95], v[176:179], a[52:55], v[80:95]
  buffer_load_dwordx4 v[176:179], v48, s[28:31], s55 offen sc1
  s_waitcnt vmcnt(15)
  v_mfma_f32_32x32x16_bf16 v[96:111], v[180:183], a[48:51], v[96:111]
  v_mfma_f32_32x32x16_bf16 v[112:127], v[180:183], a[52:55], v[112:127]
  buffer_load_dwordx4 v[180:183], v49, s[28:31], s55 offen sc1
  s_add_u32 s55, s55, 2048
  s_waitcnt vmcnt(15)
  v_mfma_f32_32x32x16_bf16 v[64:79], v[184:187], a[56:59], v[64:79]
  v_mfma_f32_32x32x16_bf16 v[80:95], v[184:187], a[60:63], v[80:95]
  buffer_load_dwordx4 v[184:187], v48, s[28:31], s55 offen sc1
  s_waitcnt vmcnt(15)
  v_mfma_f32_32x32x16_bf16 v[96:111], v[188:191], a[56:59], v[96:111]
  v_mfma_f32_32x32x16_bf16 v[112:127], v[188:191], a[60:63], v[112:127]
  buffer_load_dwordx4 v[188:191], v49, s[28:31], s55 offen sc1
  s_add_u32 s55, s55, 2048
  s_waitcnt vmcnt(15)
  v_mfma_f32_32x32x16_bf16 v[64:79], v[128:131], a[64:67], v[64:79]
  v_mfma_f32_32x32x16_bf16 v[80:95], v[128:131], a[68:71], v[80:95]
  buffer_load_dwordx4 v[128:131], v48, s[28:31], s55 offen sc1
  s_waitcnt vmcnt(15)
  v_mfma_f32_32x32x16_bf16 v[96:111], v[132:135], a[64:67], v[96:111]
  v_mfma_f32_32x32x16_bf16 v[112:127], v[132:135], a[68:71], v[112:127]
  buffer_load_dwordx4 v[132:135], v49, s[28:31], s55 offen sc1
  s_add_u32 s55, s55, 2048
  s_waitcnt vmcnt(15)
  v_mfma_f32_32x32x16_bf16 v[64:79], v[136:139], a[72:75], v[64:79]
  v_mfma_f32_32x32x16_bf16 v[80:95], v[136:139], a[76:79], v[80:95]
  buffer_load_dwordx4 v[136:139], v48, s[28:31], s55 offen sc1
  s_waitcnt vmcnt(15)
  v_mfma_f32_32x32x16_bf16 v[96:111], v[140:143], a[72:75], v[96:111]
  v_mfma_f32_32x32x16_bf16 v[112:127], v[140:143], a[76:79], v[112:127]
  buffer_load_dwordx4 v[140:143], v49, s[28:31], s55 offen sc1
  s_add_u32 s55, s55, 2048
  s_waitcnt vmcnt(15)
  v_mfma_f32_32x32x16_bf16 v[64:79], v[144:147], a[80:83], v[64:79]
  v_mfma_f32_32x32x16_bf16 v[80:95], v[144:147], a[84:87], v[80:95]
  buffer_load_dwordx4 v[144:147], v48, s[28:31], s55 offen sc1
  s_waitcnt vmcnt(15)
  v_mfma_f32_32x32x16_bf16 v[96:111], v[148:151], a[80:83], v[96:111]
  v_mfma_f32_32x32x16_bf16 v[112:127], v[148:151], a[84:87], v[112:127]
  buffer_load_dwordx4 v[148:151], v49, s[28:31], s55 offen sc1
  s_add_u32 s55, s55, 2048
  ds_read_b64_tr_b16 a[112:113], v30 offset:0
  ds_read_b64_tr_b16 a[114:115], v30 offset:1024
  ds_read_b64_tr_b16 a[116:117], v31 offset:0
  ds_read_b64_tr_b16 a[118:119], v31 offset:1024
  s_waitcnt vmcnt(15)
  v_mfma_f32_32x32x16_bf16 v[64:79], v[152:155], a[88:91], v[64:79]
  v_mfma_f32_32x32x16_bf16 v[80:95], v[152:155], a[92:95], v[80:95]
  buffer_load_dwordx4 v[152:155], v48, s[28:31], s55 offen sc1
  s_waitcnt vmcnt(15)
  v_mfma_f32_32x32x16_bf16 v[96:111], v[156:159], a[88:91], v[96:111]
  v_mfma_f32_32x32x16_bf16 v[112:127], v[156:159], a[92:95], v[112:127]
  buffer_load_dwordx4 v[156:159], v49, s[28:31], s55 offen sc1
  s_add_u32 s55, s55, 2048
  ds_read_b64_tr_b16 a[120:121], v30 offset:2048
  ds_read_b64_tr_b16 a[122:123], v30 offset:3072
  ds_read_b64_tr_b16 a[124:125], v31 offset:2048
  ds_read_b64_tr_b16 a[126:127], v31 offset:3072
  s_waitcnt vmcnt(15)
  v_mfma_f32_32x32x16_bf16 v[64:79], v[160:163], a[96:99], v[64:79]
  v_mfma_f32_32x32x16_bf16 v[80:95], v[160:163], a[100:103], v[80:95]
  buffer_load_dwordx4 v[160:163], v48, s[28:31], s55 offen sc1
  s_waitcnt vmcnt(15)
  v_mfma_f32_32x32x16_bf16 v[96:111], v[164:167], a[96:99], v[96:111]
  v_mfma_f32_32x32x16_bf16 v[112:127], v[164:167], a[100:103], v[112:127]
  buffer_load_dwordx4 v[164:167], v49, s[28:31], s55 offen sc1
  s_add_u32 s55, s55, 2048
  ds_read_b64_tr_b16 a[128:129], v30 offset:4096
  ds_read_b64_tr_b16 a[130:131], v30 offset:5120
  ds_read_b64_tr_b16 a[132:133], v31 offset:4096
  ds_read_b64_tr_b16 a[134:135], v31 offset:5120
  s_waitcnt vmcnt(15)
  v_mfma_f32_32x32x16_bf16 v[64:79], v[168:171], a[104:107], v[64:79]
  v_mfma_f32_32x32x16_bf16 v[80:95], v[168:171], a[108:111], v[80:95]
  buffer_load_dwordx4 v[168:171], v48, s[28:31], s55 offen sc1
  s_waitcnt vmcnt(15)
  v_mfma_f32_32x32x16_bf16 v[96:111], v[172:175], a[104:107], v[96:111]
  v_mfma_f32_32x32x16_bf16 v[112:127], v[172:175], a[108:111], v[112:127]
  buffer_load_dwordx4 v[172:175], v49, s[28:31], s55 offen sc1
  s_add_u32 s55, s55, 2048
  v_mov_b32 v33, 4
  s_mov_b32 s72, 12591104
  s_mov_b32 exec_lo, 0xff
  s_mov_b32 exec_hi, 0
  buffer_load_dword v34, v32, s[28:31], s72 offen sc1
  s_mov_b64 exec, -1
  ds_read_b64_tr_b16 a[136:137], v30 offset:6144
  ds_read_b64_tr_b16 a[138:139], v30 offset:7168
  ds_read_b64_tr_b16 a[140:141], v31 offset:6144
  ds_read_b64_tr_b16 a[142:143], v31 offset:7168
  s_waitcnt vmcnt(16) lgkmcnt(14)
  v_mfma_f32_32x32x16_bf16 v[64:79], v[176:179], a[112:115], v[64:79]
  s_waitcnt lgkmcnt(12)
  v_mfma_f32_32x32x16_bf16 v[80:95], v[176:179], a[116:119], v[80:95]
  buffer_load_dwordx4 v[176:179], v48, s[28:31], s55 offen sc1
  s_waitcnt vmcnt(16)
  v_mfma_f32_32x32x16_bf16 v[96:111], v[180:183], a[112:115], v[96:111]
  v_mfma_f32_32x32x16_bf16 v[112:127], v[180:183], a[116:119], v[112:127]
  buffer_load_dwordx4 v[180:183], v49, s[28:31], s55 offen sc1
  s_add_u32 s55, s55, 2048
  ds_read_b64_tr_b16 a[144:145], v30 offset:8192
  ds_read_b64_tr_b16 a[146:147], v30 offset:9216
  ds_read_b64_tr_b16 a[148:149], v31 offset:8192
  ds_read_b64_tr_b16 a[150:151], v31 offset:9216
  s_waitcnt vmcnt(16) lgkmcnt(14)
  v_mfma_f32_32x32x16_bf16 v[64:79], v[184:187], a[120:123], v[64:79]
  s_waitcnt lgkmcnt(12)
  v_mfma_f32_32x32x16_bf16 v[80:95], v[184:187], a[124:127], v[80:95]
  buffer_load_dwordx4 v[184:187], v48, s[28:31], s55 offen sc1
  s_waitcnt vmcnt(16)
  v_mfma_f32_32x32x16_bf16 v[96:111], v[188:191], a[120:123], v[96:111]
  v_mfma_f32_32x32x16_bf16 v[112:127], v[188:191], a[124:127], v[112:127]
  buffer_load_dwordx4 v[188:191], v49, s[28:31], s55 offen sc1
  s_add_u32 s55, s55, 2048
  ds_read_b64_tr_b16 a[152:153], v30 offset:10240
  ds_read_b64_tr_b16 a[154:155], v30 offset:11264
  ds_read_b64_tr_b16 a[156:157], v31 offset:10240
  ds_read_b64_tr_b16 a[158:159], v31 offset:11264
  s_waitcnt vmcnt(16) lgkmcnt(14)
  v_mfma_f32_32x32x16_bf16 v[64:79], v[128:131], a[128:131], v[64:79]
  s_waitcnt lgkmcnt(12)
  v_mfma_f32_32x32x16_bf16 v[80:95], v[128:131], a[132:135], v[80:95]
  buffer_load_dwordx4 v[128:131], v48, s[28:31], s55 offen sc1
  s_waitcnt vmcnt(16)
  v_mfma_f32_32x32x16_bf16 v[96:111], v[132:135], a[128:131], v[96:111]
  v_mfma_f32_32x32x16_bf16 v[112:127], v[132:135], a[132:135], v[112:127]
  buffer_load_dwordx4 v[132:135], v49, s[28:31], s55 offen sc1
  s_add_u32 s55, s55, 2048
  ds_read_b64_tr_b16 a[160:161], v30 offset:12288
  ds_read_b64_tr_b16 a[162:163], v30 offset:13312
  ds_read_b64_tr_b16 a[164:165], v31 offset:12288
  ds_read_b64_tr_b16 a[166:167], v31 offset:13312
  s_waitcnt vmcnt(16) lgkmcnt(14)
  v_mfma_f32_32x32x16_bf16 v[64:79], v[136:139], a[136:139], v[64:79]
  s_waitcnt lgkmcnt(12)
  v_mfma_f32_32x32x16_bf16 v[80:95], v[136:139], a[140:143], v[80:95]
  buffer_load_dwordx4 v[136:139], v48, s[28:31], s55 offen sc1
  s_waitcnt vmcnt(16)
  v_mfma_f32_32x32x16_bf16 v[96:111], v[140:143], a[136:139], v[96:111]
  v_mfma_f32_32x32x16_bf16 v[112:127], v[140:143], a[140:143], v[112:127]
  buffer_load_dwordx4 v[140:143], v49, s[28:31], s55 offen sc1
  s_add_u32 s55, s55, 2048
  ds_read_b64_tr_b16 a[168:169], v30 offset:14336
  ds_read_b64_tr_b16 a[170:171], v30 offset:15360
  ds_read_b64_tr_b16 a[172:173], v31 offset:14336
  ds_read_b64_tr_b16 a[174:175], v31 offset:15360
  s_waitcnt vmcnt(16) lgkmcnt(14)
  v_mfma_f32_32x32x16_bf16 v[64:79], v[144:147], a[144:147], v[64:79]
  s_waitcnt lgkmcnt(12)
  v_mfma_f32_32x32x16_bf16 v[80:95], v[144:147], a[148:151], v[80:95]
  buffer_load_dwordx4 v[144:147], v48, s[28:31], s55 offen sc1
  s_waitcnt vmcnt(16)
  v_mfma_f32_32x32x16_bf16 v[96:111], v[148:151], a[144:147], v[96:111]
  v_mfma_f32_32x32x16_bf16 v[112:127], v[148:151], a[148:151], v[112:127]
  buffer_load_dwordx4 v[148:151], v49, s[28:31], s55 offen sc1
  s_add_u32 s55, s55, 2048
  ds_read_b64_tr_b16 a[176:177], v30 offset:16384
  ds_read_b64_tr_b16 a[178:179], v30 offset:17408
  ds_read_b64_tr_b16 a[180:181], v31 offset:16384
  ds_read_b64_tr_b16 a[182:183], v31 offset:17408
  s_waitcnt vmcnt(16) lgkmcnt(14)
  v_mfma_f32_32x32x16_bf16 v[64:79], v[152:155], a[152:155], v[64:79]
  s_waitcnt lgkmcnt(12)
  v_mfma_f32_32x32x16_bf16 v[80:95], v[152:155], a[156:159], v[80:95]
  buffer_load_dwordx4 v[152:155], v48, s[28:31], s55 offen sc1
  s_waitcnt vmcnt(16)
  v_mfma_f32_32x32x16_bf16 v[96:111], v[156:159], a[152:155], v[96:111]
  v_mfma_f32_32x32x16_bf16 v[112:127], v[156:159], a[156:159], v[112:127]
  buffer_load_dwordx4 v[156:159], v49, s[28:31], s55 offen sc1
  s_add_u32 s55, s55, 2048
  s_mov_b32 s73, 0
  s_waitcnt vmcnt(12)
  v_mov_b32 v35, v34
  s_mov_b32 exec_lo, 0xff
  s_mov_b32 exec_hi, 0
fzg_zc_l:
  v_cmp_ge_u32 vcc, v35, v33
  s_nop 2
  s_cmp_eq_u64 vcc, exec
  s_cbranch_scc1 fzg_zc_d
  buffer_load_dword v35, v32, s[28:31], s72 offen sc1
  s_add_u32 s73, s73, 1
  s_waitcnt vmcnt(0)
  s_cmp_lt_u32 s73, 131072
  s_cbranch_scc1 fzg_zc_l
fzg_zc_d:
  s_mov_b64 exec, -1
  ds_read_b64_tr_b16 a[184:185], v30 offset:18432
  ds_read_b64_tr_b16 a[186:187], v30 offset:19456
  ds_read_b64_tr_b16 a[188:189], v31 offset:18432
  ds_read_b64_tr_b16 a[190:191], v31 offset:19456
  s_waitcnt lgkmcnt(14)
  v_mfma_f32_32x32x16_bf16 v[64:79], v[160:163], a[160:163], v[64:79]
  s_waitcnt lgkmcnt(12)
  v_mfma_f32_32x32x16_bf16 v[80:95], v[160:163], a[164:167], v[80:95]
  v_mfma_f32_32x32x16_bf16 v[96:111], v[164:167], a[160:163], v[96:111]
  v_mfma_f32_32x32x16_bf16 v[112:127], v[164:167], a[164:167], v[112:127]
  s_add_u32 m0, s98, 0
  s_nop 0
  buffer_load_dwordx4 v28, s[28:31], s51 offen sc1 lds
  buffer_load_dwordx4 v29, s[28:31], s51 offen offset:1024 sc1 lds
  s_add_u32 s51, s51, 65536
  ds_read_b64_tr_b16 a[192:193], v30 offset:20480
  ds_read_b64_tr_b16 a[194:195], v30 offset:21504
  ds_read_b64_tr_b16 a[196:197], v31 offset:20480
  ds_read_b64_tr_b16 a[198:199], v31 offset:21504
  s_waitcnt lgkmcnt(14)
  v_mfma_f32_32x32x16_bf16 v[64:79], v[168:171], a[168:171], v[64:79]
  s_waitcnt lgkmcnt(12)
  v_mfma_f32_32x32x16_bf16 v[80:95], v[168:171], a[172:175], v[80:95]
  v_mfma_f32_32x32x16_bf16 v[96:111], v[172:175], a[168:171], v[96:111]
  v_mfma_f32_32x32x16_bf16 v[112:127], v[172:175], a[172:175], v[112:127]
  s_add_u32 m0, s98, 2048
  s_nop 0
  buffer_load_dwordx4 v28, s[28:31], s51 offen sc1 lds
  buffer_load_dwordx4 v29, s[28:31], s51 offen offset:1024 sc1 lds
  s_add_u32 s51, s51, 65536
  ds_read_b64_tr_b16 a[200:201], v30 offset:22528
  ds_read_b64_tr_b16 a[202:203], v30 offset:23552
  ds_read_b64_tr_b16 a[204:205], v31 offset:22528
  ds_read_b64_tr_b16 a[206:207], v31 offset:23552
  s_waitcnt vmcnt(15) lgkmcnt(14)
  v_mfma_f32_32x32x16_bf16 v[64:79], v[176:179], a[176:179], v[64:79]
  s_waitcnt lgkmcnt(12)
  v_mfma_f32_32x32x16_bf16 v[80:95], v[176:179], a[180:183], v[80:95]
  s_waitcnt vmcnt(14)
  v_mfma_f32_32x32x16_bf16 v[96:111], v[180:183], a[176:179], v[96:111]
  v_mfma_f32_32x32x16_bf16 v[112:127], v[180:183], a[180:183], v[112:127]
  s_add_u32 m0, s98, 4096
  s_nop 0
  buffer_load_dwordx4 v28, s[28:31], s51 offen sc1 lds
  buffer_load_dwordx4 v29, s[28:31], s51 offen offset:1024 sc1 lds
  s_add_u32 s51, s51, 65536
  ds_read_b64_tr_b16 a[208:209], v30 offset:24576
  ds_read_b64_tr_b16 a[210:211], v30 offset:25600
  ds_read_b64_tr_b16 a[212:213], v31 offset:24576
  ds_read_b64_tr_b16 a[214:215], v31 offset:25600
  s_waitcnt vmcnt(15) lgkmcnt(14)
  v_mfma_f32_32x32x16_bf16 v[64:79], v[184:187], a[184:187], v[64:79]
  s_waitcnt lgkmcnt(12)
  v_mfma_f32_32x32x16_bf16 v[80:95], v[184:187], a[188:191], v[80:95]
  s_waitcnt vmcnt(14)
  v_mfma_f32_32x32x16_bf16 v[96:111], v[188:191], a[184:187], v[96:111]
  v_mfma_f32_32x32x16_bf16 v[112:127], v[188:191], a[188:191], v[112:127]
  s_add_u32 m0, s98, 6144
  s_nop 0
  buffer_load_dwordx4 v28, s[28:31], s51 offen sc1 lds
  buffer_load_dwordx4 v29, s[28:31], s51 offen offset:1024 sc1 lds
  s_add_u32 s51, s51, 65536
  ds_read_b64_tr_b16 a[216:217], v30 offset:26624
  ds_read_b64_tr_b16 a[218:219], v30 offset:27648
  ds_read_b64_tr_b16 a[220:221], v31 offset:26624
  ds_read_b64_tr_b16 a[222:223], v31 offset:27648
  s_waitcnt vmcnt(15) lgkmcnt(14)
  v_mfma_f32_32x32x16_bf16 v[64:79], v[128:131], a[192:195], v[64:79]
  s_waitcnt lgkmcnt(12)
  v_mfma_f32_32x32x16_bf16 v[80:95], v[128:131], a[196:199], v[80:95]
  s_waitcnt vmcnt(14)
  v_mfma_f32_32x32x16_bf16 v[96:111], v[132:135], a[192:195], v[96:111]
  v_mfma_f32_32x32x16_bf16 v[112:127], v[132:135], a[196:199], v[112:127]
  s_add_u32 m0, s98, 8192
  s_nop 0
  buffer_load_dwordx4 v28, s[28:31], s51 offen sc1 lds
  buffer_load_dwordx4 v29, s[28:31], s51 offen offset:1024 sc1 lds
  s_add_u32 s51, s51, 65536
  s_waitcnt vmcnt(8)
  ds_read_b64_tr_b16 a[224:225], v30 offset:0
  ds_read_b64_tr_b16 a[226:227], v30 offset:1024
  ds_read_b64_tr_b16 a[228:229], v31 offset:0
  ds_read_b64_tr_b16 a[230:231], v31 offset:1024
  s_waitcnt lgkmcnt(14)
  v_mfma_f32_32x32x16_bf16 v[64:79], v[136:139], a[200:203], v[64:79]
  s_waitcnt lgkmcnt(12)
  v_mfma_f32_32x32x16_bf16 v[80:95], v[136:139], a[204:207], v[80:95]
  v_mfma_f32_32x32x16_bf16 v[96:111], v[140:143], a[200:203], v[96:111]
  v_mfma_f32_32x32x16_bf16 v[112:127], v[140:143], a[204:207], v[112:127]
  s_add_u32 m0, s98, 10240
  s_nop 0
  buffer_load_dwordx4 v28, s[28:31], s51 offen sc1 lds
  buffer_load_dwordx4 v29, s[28:31], s51 offen offset:1024 sc1 lds
  s_add_u32 s51, s51, 65536
  s_waitcnt vmcnt(8)
  ds_read_b64_tr_b16 a[232:233], v30 offset:2048
  ds_read_b64_tr_b16 a[234:235], v30 offset:3072
  ds_read_b64_tr_b16 a[236:237], v31 offset:2048
  ds_read_b64_tr_b16 a[238:239], v31 offset:3072
  s_waitcnt lgkmcnt(14)
  v_mfma_f32_32x32x16_bf16 v[64:79], v[144:147], a[208:211], v[64:79]
  s_waitcnt lgkmcnt(12)
  v_mfma_f32_32x32x16_bf16 v[80:95], v[144:147], a[212:215], v[80:95]
  v_mfma_f32_32x32x16_bf16 v[96:111], v[148:151], a[208:211], v[96:111]
  v_mfma_f32_32x32x16_bf16 v[112:127], v[148:151], a[212:215], v[112:127]
  s_add_u32 m0, s98, 12288
  s_nop 0
  buffer_load_dwordx4 v28, s[28:31], s51 offen sc1 lds
  buffer_load_dwordx4 v29, s[28:31], s51 offen offset:1024 sc1 lds
  s_add_u32 s51, s51, 65536
  s_waitcnt vmcnt(8)
  ds_read_b64_tr_b16 a[240:241], v30 offset:4096
  ds_read_b64_tr_b16 a[242:243], v30 offset:5120
  ds_read_b64_tr_b16 a[244:245], v31 offset:4096
  ds_read_b64_tr_b16 a[246:247], v31 offset:5120
  s_waitcnt lgkmcnt(14)
  v_mfma_f32_32x32x16_bf16 v[64:79], v[152:155], a[216:219], v[64:79]
  s_waitcnt lgkmcnt(12)
  v_mfma_f32_32x32x16_bf16 v[80:95], v[152:155], a[220:223], v[80:95]
  v_mfma_f32_32x32x16_bf16 v[96:111], v[156:159], a[216:219], v[96:111]
  v_mfma_f32_32x32x16_bf16 v[112:127], v[156:159], a[220:223], v[112:127]
  s_add_u32 m0, s98, 14336
  s_nop 0
  buffer_load_dwordx4 v28, s[28:31], s51 offen sc1 lds
  buffer_load_dwordx4 v29, s[28:31], s51 offen offset:1024 sc1 lds
  s_add_u32 s51, s51, 65536
  s_waitcnt vmcnt(8)
  ds_read_b64_tr_b16 a[248:249], v30 offset:6144
  ds_read_b64_tr_b16 a[250:251], v30 offset:7168
  ds_read_b64_tr_b16 a[252:253], v31 offset:6144
  ds_read_b64_tr_b16 a[254:255], v31 offset:7168
  s_waitcnt lgkmcnt(14)
  v_mfma_f32_32x32x16_bf16 v[64:79], v[192:195], a[224:227], v[64:79]
  s_waitcnt lgkmcnt(12)
  v_mfma_f32_32x32x16_bf16 v[80:95], v[192:195], a[228:231], v[80:95]
  v_mfma_f32_32x32x16_bf16 v[96:111], v[196:199], a[224:227], v[96:111]
  v_mfma_f32_32x32x16_bf16 v[112:127], v[196:199], a[228:231], v[112:127]
  s_waitcnt vmcnt(6)
  ds_read_b64_tr_b16 a[224:225], v30 offset:8192
  ds_read_b64_tr_b16 a[226:227], v30 offset:9216
  ds_read_b64_tr_b16 a[228:229], v31 offset:8192
  ds_read_b64_tr_b16 a[230:231], v31 offset:9216
  s_waitcnt lgkmcnt(14)
  v_mfma_f32_32x32x16_bf16 v[64:79], v[200:203], a[232:235], v[64:79]
  s_waitcnt lgkmcnt(12)
  v_mfma_f32_32x32x16_bf16 v[80:95], v[200:203], a[236:239], v[80:95]
  v_mfma_f32_32x32x16_bf16 v[96:111], v[204:207], a[232:235], v[96:111]
  v_mfma_f32_32x32x16_bf16 v[112:127], v[204:207], a[236:239], v[112:127]
  s_waitcnt vmcnt(4)
  ds_read_b64_tr_b16 a[232:233], v30 offset:10240
  ds_read_b64_tr_b16 a[234:235], v30 offset:11264
  ds_read_b64_tr_b16 a[236:237], v31 offset:10240
  ds_read_b64_tr_b16 a[238:239], v31 offset:11264
  s_waitcnt lgkmcnt(14)
  v_mfma_f32_32x32x16_bf16 v[64:79], v[208:211], a[240:243], v[64:79]
  s_waitcnt lgkmcnt(12)
  v_mfma_f32_32x32x16_bf16 v[80:95], v[208:211], a[244:247], v[80:95]
  v_mfma_f32_32x32x16_bf16 v[96:111], v[212:215], a[240:243], v[96:111]
  v_mfma_f32_32x32x16_bf16 v[112:127], v[212:215], a[244:247], v[112:127]
  s_waitcnt vmcnt(2)
  ds_read_b64_tr_b16 a[240:241], v30 offset:12288
  ds_read_b64_tr_b16 a[242:243], v30 offset:13312
  ds_read_b64_tr_b16 a[244:245], v31 offset:12288
  ds_read_b64_tr_b16 a[246:247], v31 offset:13312
  s_waitcnt lgkmcnt(14)
  v_mfma_f32_32x32x16_bf16 v[64:79], v[216:219], a[248:251], v[64:79]
  s_waitcnt lgkmcnt(12)
  v_mfma_f32_32x32x16_bf16 v[80:95], v[216:219], a[252:255], v[80:95]
  v_mfma_f32_32x32x16_bf16 v[96:111], v[220:223], a[248:251], v[96:111]
  v_mfma_f32_32x32x16_bf16 v[112:127], v[220:223], a[252:255], v[112:127]
  s_waitcnt vmcnt(0)
  ds_read_b64_tr_b16 a[248:249], v30 offset:14336
  ds_read_b64_tr_b16 a[250:251], v30 offset:15360
  ds_read_b64_tr_b16 a[252:253], v31 offset:14336
  ds_read_b64_tr_b16 a[254:255], v31 offset:15360
  s_waitcnt lgkmcnt(14)
  v_mfma_f32_32x32x16_bf16 v[64:79], v[224:227], a[224:227], v[64:79]
  s_waitcnt lgkmcnt(12)
  v_mfma_f32_32x32x16_bf16 v[80:95], v[224:227], a[228:231], v[80:95]
  v_mfma_f32_32x32x16_bf16 v[96:111], v[228:231], a[224:227], v[96:111]
  v_mfma_f32_32x32x16_bf16 v[112:127], v[228:231], a[228:231], v[112:127]
  s_waitcnt lgkmcnt(10)
  v_mfma_f32_32x32x16_bf16 v[64:79], v[232:235], a[232:235], v[64:79]
  s_waitcnt lgkmcnt(8)
  v_mfma_f32_32x32x16_bf16 v[80:95], v[232:235], a[236:239], v[80:95]
  v_mfma_f32_32x32x16_bf16 v[96:111], v[236:239], a[232:235], v[96:111]
  v_mfma_f32_32x32x16_bf16 v[112:127], v[236:239], a[236:239], v[112:127]
  s_waitcnt lgkmcnt(6)
  v_mfma_f32_32x32x16_bf16 v[64:79], v[240:243], a[240:243], v[64:79]
  s_waitcnt lgkmcnt(4)
  v_mfma_f32_32x32x16_bf16 v[80:95], v[240:243], a[244:247], v[80:95]
  v_mfma_f32_32x32x16_bf16 v[96:111], v[244:247], a[240:243], v[96:111]
  v_mfma_f32_32x32x16_bf16 v[112:127], v[244:247], a[244:247], v[112:127]
  s_waitcnt lgkmcnt(2)
  v_mfma_f32_32x32x16_bf16 v[64:79], v[248:251], a[248:251], v[64:79]
  s_waitcnt lgkmcnt(0)
  v_mfma_f32_32x32x16_bf16 v[80:95], v[248:251], a[252:255], v[80:95]
  v_mfma_f32_32x32x16_bf16 v[96:111], v[252:255], a[248:251], v[96:111]
  v_mfma_f32_32x32x16_bf16 v[112:127], v[252:255], a[252:255], v[112:127]
  s_mov_b32 s40, s22
  s_and_b32 s41, s23, 0xffff
  s_mov_b32 s42, 2097152
  s_mov_b32 s43, 0x20000
  s_barrier
  s_nop 4
  ds_write_b128 v9, v[80:83] offset:0
  ds_write_b128 v9, v[84:87] offset:1024
  ds_write_b128 v9, v[88:91] offset:2048
  ds_write_b128 v9, v[92:95] offset:3072
  ds_write_b128 v10, v[96:99] offset:0
  ds_write_b128 v10, v[100:103] offset:1024
  ds_write_b128 v10, v[104:107] offset:2048
  ds_write_b128 v10, v[108:111] offset:3072
  ds_write_b128 v11, v[112:115] offset:0
  ds_write_b128 v11, v[116:119] offset:1024
  ds_write_b128 v11, v[120:123] offset:2048
  ds_write_b128 v11, v[124:127] offset:3072
  v_lshlrev_b32 v32, 16, v50
  v_and_b32 v33, 0xffff0000, v50
  v_lshlrev_b32 v34, 16, v51
  v_and_b32 v35, 0xffff0000, v51
  v_lshlrev_b32 v36, 16, v52
  v_and_b32 v37, 0xffff0000, v52
  v_lshlrev_b32 v38, 16, v53
  v_and_b32 v39, 0xffff0000, v53
  v_lshlrev_b32 v40, 16, v54
  v_and_b32 v41, 0xffff0000, v54
  v_lshlrev_b32 v42, 16, v55
  v_and_b32 v43, 0xffff0000, v55
  v_lshlrev_b32 v44, 16, v56
  v_and_b32 v45, 0xffff0000, v56
  v_lshlrev_b32 v46, 16, v57
  v_and_b32 v47, 0xffff0000, v57
  v_lshlrev_b32 v59, 16, v58
  v_lshlrev_b32 v58, 16, v58
  v_pk_add_f32 v[64:65], v[64:65], v[32:33]
  v_pk_add_f32 v[66:67], v[66:67], v[34:35]
  v_pk_add_f32 v[68:69], v[68:69], v[36:37]
  v_pk_add_f32 v[70:71], v[70:71], v[38:39]
  v_pk_add_f32 v[72:73], v[72:73], v[40:41]
  v_pk_add_f32 v[74:75], v[74:75], v[42:43]
  v_pk_add_f32 v[76:77], v[76:77], v[44:45]
  v_pk_add_f32 v[78:79], v[78:79], v[46:47]
  v_pk_add_f32 v[64:65], v[64:65], v[58:59]
  v_pk_add_f32 v[66:67], v[66:67], v[58:59]
  v_pk_add_f32 v[68:69], v[68:69], v[58:59]
  v_pk_add_f32 v[70:71], v[70:71], v[58:59]
  v_pk_add_f32 v[72:73], v[72:73], v[58:59]
  v_pk_add_f32 v[74:75], v[74:75], v[58:59]
  v_pk_add_f32 v[76:77], v[76:77], v[58:59]
  v_pk_add_f32 v[78:79], v[78:79], v[58:59]
  s_waitcnt lgkmcnt(0)
  s_barrier
  ds_read_b128 v[128:131], v12 offset:0
  ds_read_b128 v[132:135], v12 offset:1024
  ds_read_b128 v[136:139], v12 offset:2048
  ds_read_b128 v[140:143], v12 offset:3072
  ds_read_b128 v[144:147], v12 offset:4096
  ds_read_b128 v[148:151], v12 offset:5120
  ds_read_b128 v[152:155], v12 offset:6144
  ds_read_b128 v[156:159], v12 offset:7168
  ds_read_b128 v[160:163], v12 offset:8192
  ds_read_b128 v[164:167], v12 offset:9216
  ds_read_b128 v[168:171], v12 offset:10240
  ds_read_b128 v[172:175], v12 offset:11264
  s_waitcnt lgkmcnt(8)
  v_pk_add_f32 v[64:65], v[64:65], v[128:129]
  v_pk_add_f32 v[66:67], v[66:67], v[130:131]
  v_pk_add_f32 v[68:69], v[68:69], v[132:133]
  v_pk_add_f32 v[70:71], v[70:71], v[134:135]
  v_pk_add_f32 v[72:73], v[72:73], v[136:137]
  v_pk_add_f32 v[74:75], v[74:75], v[138:139]
  v_pk_add_f32 v[76:77], v[76:77], v[140:141]
  v_pk_add_f32 v[78:79], v[78:79], v[142:143]
  s_waitcnt lgkmcnt(4)
  v_pk_add_f32 v[64:65], v[64:65], v[144:145]
  v_pk_add_f32 v[66:67], v[66:67], v[146:147]
  v_pk_add_f32 v[68:69], v[68:69], v[148:149]
  v_pk_add_f32 v[70:71], v[70:71], v[150:151]
  v_pk_add_f32 v[72:73], v[72:73], v[152:153]
  v_pk_add_f32 v[74:75], v[74:75], v[154:155]
  v_pk_add_f32 v[76:77], v[76:77], v[156:157]
  v_pk_add_f32 v[78:79], v[78:79], v[158:159]
  s_waitcnt lgkmcnt(0)
  v_pk_add_f32 v[64:65], v[64:65], v[160:161]
  v_pk_add_f32 v[66:67], v[66:67], v[162:163]
  v_pk_add_f32 v[68:69], v[68:69], v[164:165]
  v_pk_add_f32 v[70:71], v[70:71], v[166:167]
  v_pk_add_f32 v[72:73], v[72:73], v[168:169]
  v_pk_add_f32 v[74:75], v[74:75], v[170:171]
  v_pk_add_f32 v[76:77], v[76:77], v[172:173]
  v_pk_add_f32 v[78:79], v[78:79], v[174:175]
  v_cvt_pk_bf16_f32 v16, v64, v65
  v_cvt_pk_bf16_f32 v17, v66, v67
  v_cvt_pk_bf16_f32 v18, v68, v69
  v_cvt_pk_bf16_f32 v19, v70, v71
  v_cvt_pk_bf16_f32 v20, v72, v73
  v_cvt_pk_bf16_f32 v21, v74, v75
  v_cvt_pk_bf16_f32 v22, v76, v77
  v_cvt_pk_bf16_f32 v23, v78, v79
  buffer_store_dwordx4 v[16:19], v60, s[40:43], s59 offen
  buffer_store_dwordx4 v[20:23], v60, s[40:43], s59 offen offset:16
  s_branch fz_end
fz_fft:
  s_waitcnt vmcnt(8)
  s_barrier
  s_cmp_lg_u32 s3, 0
  s_cbranch_scc1 fzf_siga_skip
  s_mov_b32 s73, 0
  s_mov_b64 exec, 1
fzf_rdy:
  v_cmp_ne_u32 vcc, 0, v251
  s_nop 2
  s_cmp_eq_u64 vcc, exec
  s_cbranch_scc1 fzf_rdy_done
  buffer_load_dword v251, v250, s[40:43], 0 offen sc1
  s_add_u32 s73, s73, 1
  s_waitcnt vmcnt(0)
  s_cmp_lt_u32 s73, 131072
  s_cbranch_scc1 fzf_rdy
fzf_rdy_done:
  s_and_b32 s72, s2, 31
  s_lshl_b32 s72, s72, 7
  s_add_u32 s72, s72, 12582912
  v_mov_b32 v251, 1
  buffer_atomic_add v251, v250, s[28:31], s72 offen sc1
  s_mov_b64 exec, -1
fzf_siga_skip:
  v_and_b32 v24, 31, v1
  v_lshrrev_b32 v25, 5, v1
  v_bfe_u32 v26, v24, 2, 1
  v_lshlrev_b32 v26, 4, v26
  v_lshrrev_b32 v27, 3, v24
  v_lshlrev_b32 v27, 2, v27
  v_add_u32 v26, v26, v27
  v_and_b32 v27, 3, v24
  v_add_u32 v26, v26, v27
  v_lshlrev_b32 v33, 4, v1
  s_mov_b32 s44, s3
fz_t64:
  s_lshr_b32 s45, s44, 1
  s_and_b32 s46, s44, 1
  s_lshl_b32 s46, s46, 5
  v_add_u32 v28, s46, v24
  s_lshl_b32 s46, s45, 4
  v_lshlrev_b32 v29, 2, v25
  v_add_u32 v29, s46, v29
  s_lshl_b32 s47, s44, 10
  s_add_u32 s47, s47, 49152
  v_cvt_f32_u32 v35, v28
  v_mul_f32 v35, 0x3c800000, v35
  v_add_u32 v30, 0, v29
  v_cvt_f32_u32 v30, v30
  v_mul_f32 v30, v30, v35
  v_fract_f32 v30, v30
  v_cos_f32 v40, v30
  v_sin_f32 v48, v30
  v_add_u32 v30, 1, v29
  v_cvt_f32_u32 v30, v30
  v_mul_f32 v30, v30, v35
  v_fract_f32 v30, v30
  v_cos_f32 v41, v30
  v_sin_f32 v49, v30
  v_add_u32 v30, 2, v29
  v_cvt_f32_u32 v30, v30
  v_mul_f32 v30, v30, v35
  v_fract_f32 v30, v30
  v_cos_f32 v42, v30
  v_sin_f32 v50, v30
  v_add_u32 v30, 3, v29
  v_cvt_f32_u32 v30, v30
  v_mul_f32 v30, v30, v35
  v_fract_f32 v30, v30
  v_cos_f32 v43, v30
  v_sin_f32 v51, v30
  v_add_u32 v30, 8, v29
  v_cvt_f32_u32 v30, v30
  v_mul_f32 v30, v30, v35
  v_fract_f32 v30, v30
  v_cos_f32 v44, v30
  v_sin_f32 v52, v30
  v_add_u32 v30, 9, v29
  v_cvt_f32_u32 v30, v30
  v_mul_f32 v30, v30, v35
  v_fract_f32 v30, v30
  v_cos_f32 v45, v30
  v_sin_f32 v53, v30
  v_add_u32 v30, 10, v29
  v_cvt_f32_u32 v30, v30
  v_mul_f32 v30, v30, v35
  v_fract_f32 v30, v30
  v_cos_f32 v46, v30
  v_sin_f32 v54, v30
  v_add_u32 v30, 11, v29
  v_cvt_f32_u32 v30, v30
  v_mul_f32 v30, v30, v35
  v_fract_f32 v30, v30
  v_cos_f32 v47, v30
  v_sin_f32 v55, v30
  v_cvt_pk_bf16_f32 v36, v40, v41
  v_cvt_pk_bf16_f32 v37, v42, v43
  v_cvt_pk_bf16_f32 v38, v44, v45
  v_cvt_pk_bf16_f32 v39, v46, v47
  v_cvt_pk_bf16_f32 v56, v48, v49
  v_cvt_pk_bf16_f32 v57, v50, v51
  v_cvt_pk_bf16_f32 v58, v52, v53
  v_cvt_pk_bf16_f32 v59, v54, v55
  v_cvt_pk_bf16_f32 v60, -v48, -v49
  v_cvt_pk_bf16_f32 v61, -v50, -v51
  v_cvt_pk_bf16_f32 v62, -v52, -v53
  v_cvt_pk_bf16_f32 v63, -v54, -v55
  v_add_u32 v34, s47, v33
  ds_write_b128 v34, v[36:39]
  ds_write_b128 v34, v[56:59] offset:8192
  ds_write_b128 v34, v[60:63] offset:16384
  s_add_u32 s44, s44, 4
  s_cmp_lt_u32 s44, 8
  s_cbranch_scc1 fz_t64
  s_and_b32 s44, s3, 1
  s_lshl_b32 s46, s44, 3
  v_lshlrev_b32 v29, 4, v25
  v_add_u32 v29, s46, v29
  s_lshl_b32 s47, s44, 10
  s_add_u32 s47, s47, 73728
  v_cvt_f32_u32 v35, v26
  v_mul_f32 v35, 0x3d000000, v35
  v_add_u32 v30, 0, v29
  v_cvt_f32_u32 v30, v30
  v_mul_f32 v30, v30, v35
  v_fract_f32 v30, v30
  v_cos_f32 v40, v30
  v_sin_f32 v48, v30
  v_add_u32 v30, 1, v29
  v_cvt_f32_u32 v30, v30
  v_mul_f32 v30, v30, v35
  v_fract_f32 v30, v30
  v_cos_f32 v41, v30
  v_sin_f32 v49, v30
  v_add_u32 v30, 2, v29
  v_cvt_f32_u32 v30, v30
  v_mul_f32 v30, v30, v35
  v_fract_f32 v30, v30
  v_cos_f32 v42, v30
  v_sin_f32 v50, v30
  v_add_u32 v30, 3, v29
  v_cvt_f32_u32 v30, v30
  v_mul_f32 v30, v30, v35
  v_fract_f32 v30, v30
  v_cos_f32 v43, v30
  v_sin_f32 v51, v30
  v_add_u32 v30, 4, v29
  v_cvt_f32_u32 v30, v30
  v_mul_f32 v30, v30, v35
  v_fract_f32 v30, v30
  v_cos_f32 v44, v30
  v_sin_f32 v52, v30
  v_add_u32 v30, 5, v29
  v_cvt_f32_u32 v30, v30
  v_mul_f32 v30, v30, v35
  v_fract_f32 v30, v30
  v_cos_f32 v45, v30
  v_sin_f32 v53, v30
  v_add_u32 v30, 6, v29
  v_cvt_f32_u32 v30, v30
  v_mul_f32 v30, v30, v35
  v_fract_f32 v30, v30
  v_cos_f32 v46, v30
  v_sin_f32 v54, v30
  v_add_u32 v30, 7, v29
  v_cvt_f32_u32 v30, v30
  v_mul_f32 v30, v30, v35
  v_fract_f32 v30, v30
  v_cos_f32 v47, v30
  v_sin_f32 v55, v30
  v_cvt_pk_bf16_f32 v36, v40, v41
  v_cvt_pk_bf16_f32 v37, v42, v43
  v_cvt_pk_bf16_f32 v38, v44, v45
  v_cvt_pk_bf16_f32 v39, v46, v47
  v_cvt_pk_bf16_f32 v56, v48, v49
  v_cvt_pk_bf16_f32 v57, v50, v51
  v_cvt_pk_bf16_f32 v58, v52, v53
  v_cvt_pk_bf16_f32 v59, v54, v55
  v_cvt_pk_bf16_f32 v60, -v48, -v49
  v_cvt_pk_bf16_f32 v61, -v50, -v51
  v_cvt_pk_bf16_f32 v62, -v52, -v53
  v_cvt_pk_bf16_f32 v63, -v54, -v55
  v_add_u32 v34, s47, v33
  ds_write_b128 v34, v[36:39]
  ds_write_b128 v34, v[56:59] offset:2048
  ds_write_b128 v34, v[60:63] offset:4096
  s_mov_b32 s44, s3
fz_tw:
  s_lshr_b32 s45, s44, 3
  s_and_b32 s46, s44, 7
  s_lshl_b32 s47, s45, 5
  v_add_u32 v28, s47, v24
  v_lshlrev_b32 v29, 4, v25
  s_lshl_b32 s48, s46, 1
  v_add_u32 v29, s48, v29
  v_add_u32 v30, 1, v29
  v_mul_u32_u24 v29, v29, v28
  v_mul_u32_u24 v30, v30, v28
  s_lshr_b32 s48, s46, 1
  s_lshl_b32 s48, s48, 3
  s_add_u32 s47, s47, s48
  s_and_b32 s48, s46, 1
  s_lshl_b32 s48, s48, 1
  s_add_u32 s47, s47, s48
  v_lshlrev_b32 v31, 2, v25
  v_add_u32 v31, s47, v31
  v_add_u32 v32, 1, v31
  v_mul_u32_u24 v31, v31, v26
  v_mul_u32_u24 v32, v32, v26
  v_cvt_f32_u32 v29, v29
  v_cvt_f32_u32 v30, v30
  v_cvt_f32_u32 v31, v31
  v_cvt_f32_u32 v32, v32
  v_mul_f32 v29, 0x3a000000, v29
  v_mul_f32 v30, 0x3a000000, v30
  v_mul_f32 v31, 0x3a000000, v31
  v_mul_f32 v32, 0x3a000000, v32
  v_cos_f32 v36, v29
  v_cos_f32 v37, v30
  v_sin_f32 v38, v29
  v_sin_f32 v39, v30
  v_cos_f32 v40, v31
  v_cos_f32 v41, v32
  v_sin_f32 v42, v31
  v_sin_f32 v43, v32
  v_mul_f32 v40, 0x35800000, v40
  v_mul_f32 v41, 0x35800000, v41
  v_mul_f32 v42, 0x35800000, v42
  v_mul_f32 v43, 0x35800000, v43
  s_lshl_b32 s47, s44, 10
  v_add_u32 v34, s47, v33
  ds_write_b128 v34, v[36:39] offset:0
  ds_write_b128 v34, v[40:43] offset:16384
  s_add_u32 s44, s44, 4
  s_cmp_lt_u32 s44, 16
  s_cbranch_scc1 fz_tw
  s_waitcnt lgkmcnt(0)
  s_barrier
  v_lshlrev_b32 v2, 4, v1
  v_add_u32 v3, 49152, v2
  ds_read_b128 a[0:3], v3 offset:0
  ds_read_b128 a[32:35], v3 offset:8192
  ds_read_b128 a[64:67], v3 offset:16384
  s_waitcnt lgkmcnt(6)
  ds_read_b128 a[4:7], v3 offset:1024
  ds_read_b128 a[36:39], v3 offset:9216
  ds_read_b128 a[68:71], v3 offset:17408
  s_waitcnt lgkmcnt(6)
  ds_read_b128 a[8:11], v3 offset:2048
  ds_read_b128 a[40:43], v3 offset:10240
  ds_read_b128 a[72:75], v3 offset:18432
  s_waitcnt lgkmcnt(6)
  ds_read_b128 a[12:15], v3 offset:3072
  ds_read_b128 a[44:47], v3 offset:11264
  ds_read_b128 a[76:79], v3 offset:19456
  s_waitcnt lgkmcnt(6)
  ds_read_b128 a[16:19], v3 offset:4096
  ds_read_b128 a[48:51], v3 offset:12288
  ds_read_b128 a[80:83], v3 offset:20480
  s_waitcnt lgkmcnt(6)
  ds_read_b128 a[20:23], v3 offset:5120
  ds_read_b128 a[52:55], v3 offset:13312
  ds_read_b128 a[84:87], v3 offset:21504
  s_waitcnt lgkmcnt(6)
  ds_read_b128 a[24:27], v3 offset:6144
  ds_read_b128 a[56:59], v3 offset:14336
  ds_read_b128 a[88:91], v3 offset:22528
  s_waitcnt lgkmcnt(6)
  ds_read_b128 a[28:31], v3 offset:7168
  ds_read_b128 a[60:63], v3 offset:15360
  ds_read_b128 a[92:95], v3 offset:23552
  s_waitcnt lgkmcnt(6)
  ds_read_b128 a[96:99], v3 offset:24576
  ds_read_b128 a[100:103], v3 offset:26624
  ds_read_b128 a[104:107], v3 offset:28672
  ds_read_b128 a[108:111], v3 offset:25600
  ds_read_b128 a[112:115], v3 offset:27648
  ds_read_b128 a[116:119], v3 offset:29696
  s_waitcnt lgkmcnt(0)
  s_cmp_lg_u32 s3, 0
  s_cbranch_scc1 fz_pf_skip
  v_lshlrev_b32 v250, 7, v1
  v_mov_b32 v251, 8
  s_mov_b32 s72, 12582912
  s_mov_b32 s73, 0
  s_mov_b32 exec_lo, 0xffffffff
  s_mov_b32 exec_hi, 0
fz_pf_loop:
  buffer_load_dword v252, v250, s[28:31], s72 offen sc1
  s_add_u32 s73, s73, 1
  s_waitcnt vmcnt(0)
  v_cmp_ge_u32 vcc, v252, v251
  s_nop 2
  s_cmp_eq_u64 vcc, exec
  s_cbranch_scc1 fz_pf_done
  s_cmp_lt_u32 s73, 131072
  s_cbranch_scc1 fz_pf_loop
fz_pf_done:
  s_mov_b64 exec, -1
fz_pf_skip:
  s_barrier
  s_lshl_b32 s43, s64, 2
  s_add_u32 s43, s43, s65
  s_lshl_b32 s44, s43, 3
  s_add_u32 s44, s44, s3
  v_lshlrev_b32 v2, 4, v1
  s_lshl_b32 s45, s44, 13
  s_add_u32 s47, s45, 9437184
  s_add_u32 s48, s45, 7340032
  s_add_u32 s49, s48, 4096
  s_add_u32 s50, s48, 32768
  s_add_u32 s51, s50, 4096
  s_lshl_b32 s46, s43, 8
  s_lshl_b32 s52, s3, 19
  s_add_u32 s46, s46, s52
  s_add_u32 s46, s46, 5242880
  s_lshl_b32 s52, s3, 14
  s_add_u32 s53, s52, 98304
  v_lshrrev_b32 v8, 4, v1
  v_and_b32 v9, 15, v1
  v_lshlrev_b32 v10, 13, v8
  v_add_u32 v11, 0, v8
  v_xor_b32 v11, v11, v9
  v_lshlrev_b32 v11, 4, v11
  v_add_u32 v20, v10, v11
  v_add_u32 v11, 4, v8
  v_xor_b32 v11, v11, v9
  v_lshlrev_b32 v11, 4, v11
  v_add_u32 v21, v10, v11
  v_add_u32 v11, 8, v8
  v_xor_b32 v11, v11, v9
  v_lshlrev_b32 v11, 4, v11
  v_add_u32 v22, v10, v11
  v_add_u32 v11, 12, v8
  v_xor_b32 v11, v11, v9
  v_lshlrev_b32 v11, 4, v11
  v_add_u32 v23, v10, v11
  s_add_u32 m0, s53, 0
  s_nop 0
  buffer_load_dwordx4 v20, s[28:31], s46 offen sc1 lds
  s_add_u32 s46, s46, 32768
  s_add_u32 m0, s53, 1024
  s_nop 0
  buffer_load_dwordx4 v21, s[28:31], s46 offen sc1 lds
  s_add_u32 s46, s46, 32768
  s_add_u32 m0, s53, 2048
  s_nop 0
  buffer_load_dwordx4 v22, s[28:31], s46 offen sc1 lds
  s_add_u32 s46, s46, 32768
  s_add_u32 m0, s53, 3072
  s_nop 0
  buffer_load_dwordx4 v23, s[28:31], s46 offen sc1 lds
  s_add_u32 s46, s46, 32768
  s_add_u32 m0, s53, 4096
  s_nop 0
  buffer_load_dwordx4 v20, s[28:31], s46 offen sc1 lds
  s_add_u32 s46, s46, 32768
  s_add_u32 m0, s53, 5120
  s_nop 0
  buffer_load_dwordx4 v21, s[28:31], s46 offen sc1 lds
  s_add_u32 s46, s46, 32768
  s_add_u32 m0, s53, 6144
  s_nop 0
  buffer_load_dwordx4 v22, s[28:31], s46 offen sc1 lds
  s_add_u32 s46, s46, 32768
  s_add_u32 m0, s53, 7168
  s_nop 0
  buffer_load_dwordx4 v23, s[28:31], s46 offen sc1 lds
  s_add_u32 s46, s46, 32768
  s_add_u32 m0, s53, 8192
  s_nop 0
  buffer_load_dwordx4 v20, s[28:31], s46 offen sc1 lds
  s_add_u32 s46, s46, 32768
  s_add_u32 m0, s53, 9216
  s_nop 0
  buffer_load_dwordx4 v21, s[28:31], s46 offen sc1 lds
  s_add_u32 s46, s46, 32768
  s_add_u32 m0, s53, 10240
  s_nop 0
  buffer_load_dwordx4 v22, s[28:31], s46 offen sc1 lds
  s_add_u32 s46, s46, 32768
  s_add_u32 m0, s53, 11264
  s_nop 0
  buffer_load_dwordx4 v23, s[28:31], s46 offen sc1 lds
  s_add_u32 s46, s46, 32768
  s_add_u32 m0, s53, 12288
  s_nop 0
  buffer_load_dwordx4 v20, s[28:31], s46 offen sc1 lds
  s_add_u32 s46, s46, 32768
  s_add_u32 m0, s53, 13312
  s_nop 0
  buffer_load_dwordx4 v21, s[28:31], s46 offen sc1 lds
  s_add_u32 s46, s46, 32768
  s_add_u32 m0, s53, 14336
  s_nop 0
  buffer_load_dwordx4 v22, s[28:31], s46 offen sc1 lds
  s_add_u32 s46, s46, 32768
  s_add_u32 m0, s53, 15360
  s_nop 0
  buffer_load_dwordx4 v23, s[28:31], s46 offen sc1 lds
  s_add_u32 s46, s46, 32768
  v_lshrrev_b32 v8, 5, v1
  v_lshlrev_b32 v8, 2, v8
  v_bfe_u32 v9, v1, 2, 2
  v_add_u32 v8, v8, v9
  v_lshlrev_b32 v8, 2, v8
  v_and_b32 v10, 1, v1
  v_lshlrev_b32 v10, 1, v10
  v_bfe_u32 v11, v1, 4, 1
  v_add_u32 v10, v10, v11
  v_add_u32 v8, v8, v10
  v_lshlrev_b32 v8, 8, v8
  v_lshlrev_b32 v9, 2, v9
  v_add_u32 v9, v9, v10
  s_lshl_b32 s52, s3, 1
  v_xor_b32 v9, s52, v9
  v_lshlrev_b32 v9, 4, v9
  v_add_u32 v8, v8, v9
  v_bfe_u32 v9, v1, 1, 1
  v_lshlrev_b32 v9, 3, v9
  v_add_u32 v8, v8, v9
  v_add_u32 v3, 98304, v8
  v_xor_b32 v5, 16, v3
  v_xor_b32 v6, 128, v3
  v_xor_b32 v7, 144, v3
  v_and_b32 v8, 31, v1
  v_lshlrev_b32 v8, 6, v8
  v_lshrrev_b32 v9, 5, v1
  v_lshlrev_b32 v9, 5, v9
  v_add_u32 v4, v8, v9
  s_waitcnt vmcnt(0)
  s_barrier
  ds_read_b64_tr_b16 a[120:121], v3 offset:0
  ds_read_b64_tr_b16 a[122:123], v3 offset:8192
  ds_read_b64_tr_b16 a[136:137], v5 offset:0
  ds_read_b64_tr_b16 a[138:139], v5 offset:8192
  ds_read_b64_tr_b16 a[124:125], v3 offset:16384
  ds_read_b64_tr_b16 a[126:127], v3 offset:24576
  ds_read_b64_tr_b16 a[140:141], v5 offset:16384
  ds_read_b64_tr_b16 a[142:143], v5 offset:24576
  ds_read_b64_tr_b16 a[128:129], v3 offset:32768
  ds_read_b64_tr_b16 a[130:131], v3 offset:40960
  ds_read_b64_tr_b16 a[144:145], v5 offset:32768
  ds_read_b64_tr_b16 a[146:147], v5 offset:40960
  ds_read_b64_tr_b16 a[132:133], v3 offset:49152
  ds_read_b64_tr_b16 a[134:135], v3 offset:57344
  ds_read_b64_tr_b16 a[148:149], v5 offset:49152
  ds_read_b64_tr_b16 a[150:151], v5 offset:57344
  s_waitcnt lgkmcnt(14)
  v_mfma_f32_32x32x16_bf16 v[64:79], a[120:123], a[0:3], 0
  ds_read_b64_tr_b16 a[152:153], v6 offset:0
  ds_read_b64_tr_b16 a[154:155], v6 offset:8192
  s_waitcnt lgkmcnt(14)
  v_mfma_f32_32x32x16_bf16 v[80:95], a[136:139], a[0:3], 0
  ds_read_b64_tr_b16 a[168:169], v7 offset:0
  v_mfma_f32_32x32x16_bf16 v[64:79], a[136:139], a[32:35], v[64:79]
  ds_read_b64_tr_b16 a[170:171], v7 offset:8192
  v_mfma_f32_32x32x16_bf16 v[80:95], a[120:123], a[64:67], v[80:95]
  ds_read_b64_tr_b16 a[156:157], v6 offset:16384
  ds_read_b64_tr_b16 a[158:159], v6 offset:24576
  s_waitcnt lgkmcnt(15)
  v_mfma_f32_32x32x16_bf16 v[64:79], a[124:127], a[8:11], v[64:79]
  ds_read_b64_tr_b16 a[172:173], v7 offset:16384
  s_waitcnt lgkmcnt(15)
  v_mfma_f32_32x32x16_bf16 v[80:95], a[140:143], a[8:11], v[80:95]
  ds_read_b64_tr_b16 a[174:175], v7 offset:24576
  v_mfma_f32_32x32x16_bf16 v[64:79], a[140:143], a[40:43], v[64:79]
  ds_read_b64_tr_b16 a[160:161], v6 offset:32768
  ds_read_b64_tr_b16 a[162:163], v6 offset:40960
  v_mfma_f32_32x32x16_bf16 v[80:95], a[124:127], a[72:75], v[80:95]
  ds_read_b64_tr_b16 a[176:177], v7 offset:32768
  s_waitcnt lgkmcnt(15)
  v_mfma_f32_32x32x16_bf16 v[64:79], a[128:131], a[16:19], v[64:79]
  ds_read_b64_tr_b16 a[178:179], v7 offset:40960
  v_mfma_f32_32x32x16_bf16 v[80:95], a[144:147], a[16:19], v[80:95]
  ds_read_b64_tr_b16 a[164:165], v6 offset:49152
  ds_read_b64_tr_b16 a[166:167], v6 offset:57344
  v_mfma_f32_32x32x16_bf16 v[64:79], a[144:147], a[48:51], v[64:79]
  ds_read_b64_tr_b16 a[180:181], v7 offset:49152
  v_mfma_f32_32x32x16_bf16 v[80:95], a[128:131], a[80:83], v[80:95]
  ds_read_b64_tr_b16 a[182:183], v7 offset:57344
  s_waitcnt lgkmcnt(15)
  v_mfma_f32_32x32x16_bf16 v[64:79], a[132:135], a[24:27], v[64:79]
  s_add_u32 s54, s47, 0
  buffer_load_dwordx4 v[24:27], v2, s[28:31], s54 offen offset:0 sc1
  v_mfma_f32_32x32x16_bf16 v[80:95], a[148:151], a[24:27], v[80:95]
  buffer_load_dwordx4 v[28:31], v2, s[28:31], s54 offen offset:1024 sc1
  v_mfma_f32_32x32x16_bf16 v[64:79], a[148:151], a[56:59], v[64:79]
  buffer_load_dwordx4 v[32:35], v2, s[28:31], s54 offen offset:2048 sc1
  v_mfma_f32_32x32x16_bf16 v[80:95], a[132:135], a[88:91], v[80:95]
  buffer_load_dwordx4 v[36:39], v2, s[28:31], s54 offen offset:3072 sc1
  s_waitcnt lgkmcnt(14)
  v_mfma_f32_32x32x16_bf16 v[96:111], a[152:155], a[0:3], 0
  s_add_u32 s54, s47, 32768
  s_waitcnt lgkmcnt(12)
  v_mfma_f32_32x32x16_bf16 v[112:127], a[168:171], a[0:3], 0
  buffer_load_dwordx4 v[40:43], v2, s[28:31], s54 offen offset:0 sc1
  v_mfma_f32_32x32x16_bf16 v[96:111], a[168:171], a[32:35], v[96:111]
  buffer_load_dwordx4 v[44:47], v2, s[28:31], s54 offen offset:1024 sc1
  v_mfma_f32_32x32x16_bf16 v[112:127], a[152:155], a[64:67], v[112:127]
  buffer_load_dwordx4 v[48:51], v2, s[28:31], s54 offen offset:2048 sc1
  s_waitcnt lgkmcnt(10)
  v_mfma_f32_32x32x16_bf16 v[96:111], a[156:159], a[8:11], v[96:111]
  buffer_load_dwordx4 v[52:55], v2, s[28:31], s54 offen offset:3072 sc1
  s_waitcnt lgkmcnt(8)
  v_mfma_f32_32x32x16_bf16 v[112:127], a[172:175], a[8:11], v[112:127]
  s_add_u32 s54, s47, 4096
  v_mfma_f32_32x32x16_bf16 v[96:111], a[172:175], a[40:43], v[96:111]
  buffer_load_dwordx4 a[184:187], v2, s[28:31], s54 offen offset:0 sc1
  v_mfma_f32_32x32x16_bf16 v[112:127], a[156:159], a[72:75], v[112:127]
  buffer_load_dwordx4 a[188:191], v2, s[28:31], s54 offen offset:1024 sc1
  s_waitcnt lgkmcnt(6)
  v_mfma_f32_32x32x16_bf16 v[96:111], a[160:163], a[16:19], v[96:111]
  buffer_load_dwordx4 a[192:195], v2, s[28:31], s54 offen offset:2048 sc1
  s_waitcnt lgkmcnt(4)
  v_mfma_f32_32x32x16_bf16 v[112:127], a[176:179], a[16:19], v[112:127]
  buffer_load_dwordx4 a[196:199], v2, s[28:31], s54 offen offset:3072 sc1
  v_mfma_f32_32x32x16_bf16 v[96:111], a[176:179], a[48:51], v[96:111]
  s_add_u32 s54, s47, 36864
  v_mfma_f32_32x32x16_bf16 v[112:127], a[160:163], a[80:83], v[112:127]
  buffer_load_dwordx4 a[200:203], v2, s[28:31], s54 offen offset:0 sc1
  s_waitcnt lgkmcnt(2)
  v_mfma_f32_32x32x16_bf16 v[96:111], a[164:167], a[24:27], v[96:111]
  buffer_load_dwordx4 a[204:207], v2, s[28:31], s54 offen offset:1024 sc1
  s_waitcnt lgkmcnt(0)
  v_mfma_f32_32x32x16_bf16 v[112:127], a[180:183], a[24:27], v[112:127]
  buffer_load_dwordx4 a[208:211], v2, s[28:31], s54 offen offset:2048 sc1
  v_mfma_f32_32x32x16_bf16 v[96:111], a[180:183], a[56:59], v[96:111]
  buffer_load_dwordx4 a[212:215], v2, s[28:31], s54 offen offset:3072 sc1
  v_mfma_f32_32x32x16_bf16 v[112:127], a[164:167], a[88:91], v[112:127]
  s_waitcnt lgkmcnt(0)
  s_barrier
  s_lshl_b32 s52, s3, 12
  s_add_u32 s52, s52, 32768
  v_add_u32 v5, s52, v4
  v_add_u32 v6, s52, v2
  v_mfma_f32_32x32x16_bf16 v[128:143], a[120:123], a[4:7], 0
  v_mfma_f32_32x32x16_bf16 v[144:159], a[136:139], a[4:7], 0
  ds_read_b128 v[8:11], v2 offset:0
  ds_read_b128 v[12:15], v2 offset:1024
  ds_read_b128 v[16:19], v2 offset:2048
  ds_read_b128 v[20:23], v2 offset:3072
  s_waitcnt lgkmcnt(3)
  v_mul_f32 v56, v64, v8
  v_mul_f32 v58, v65, v9
  v_mfma_f32_32x32x16_bf16 v[128:143], a[136:139], a[36:39], v[128:143]
  v_mul_f32 v57, v64, v10
  v_mul_f32 v59, v65, v11
  v_fmac_f32 v56, v80, v10
  v_fmac_f32 v58, v81, v11
  v_fma_f32 v57, v80, v8, -v57
  v_mfma_f32_32x32x16_bf16 v[144:159], a[120:123], a[68:71], v[144:159]
  v_fma_f32 v59, v81, v9, -v59
  v_cvt_pk_bf16_f32 v192, v56, v58
  v_cvt_pk_bf16_f32 v200, v57, v59
  v_mul_f32 v60, v96, v8
  v_mul_f32 v62, v97, v9
  v_mul_f32 v61, v96, v10
  v_mfma_f32_32x32x16_bf16 v[128:143], a[124:127], a[12:15], v[128:143]
  v_mul_f32 v63, v97, v11
  v_fmac_f32 v60, v112, v10
  v_fmac_f32 v62, v113, v11
  v_fma_f32 v61, v112, v8, -v61
  v_fma_f32 v63, v113, v9, -v63
  v_mfma_f32_32x32x16_bf16 v[144:159], a[140:143], a[12:15], v[144:159]
  v_cvt_pk_bf16_f32 v208, v60, v62
  v_cvt_pk_bf16_f32 v216, v61, v63
  ds_read_b128 v[8:11], v2 offset:4096
  s_waitcnt lgkmcnt(3)
  v_mul_f32 v56, v66, v12
  v_mul_f32 v58, v67, v13
  v_mul_f32 v57, v66, v14
  v_mfma_f32_32x32x16_bf16 v[128:143], a[140:143], a[44:47], v[128:143]
  v_mul_f32 v59, v67, v15
  v_fmac_f32 v56, v82, v14
  v_fmac_f32 v58, v83, v15
  v_fma_f32 v57, v82, v12, -v57
  v_fma_f32 v59, v83, v13, -v59
  v_mfma_f32_32x32x16_bf16 v[144:159], a[124:127], a[76:79], v[144:159]
  v_cvt_pk_bf16_f32 v193, v56, v58
  v_cvt_pk_bf16_f32 v201, v57, v59
  v_mul_f32 v60, v98, v12
  v_mul_f32 v62, v99, v13
  v_mul_f32 v61, v98, v14
  v_mfma_f32_32x32x16_bf16 v[128:143], a[128:131], a[20:23], v[128:143]
  v_mul_f32 v63, v99, v15
  v_fmac_f32 v60, v114, v14
  v_fmac_f32 v62, v115, v15
  v_fma_f32 v61, v114, v12, -v61
  v_fma_f32 v63, v115, v13, -v63
  v_cvt_pk_bf16_f32 v209, v60, v62
  v_mfma_f32_32x32x16_bf16 v[144:159], a[144:147], a[20:23], v[144:159]
  v_cvt_pk_bf16_f32 v217, v61, v63
  ds_read_b128 v[12:15], v2 offset:5120
  s_waitcnt lgkmcnt(3)
  v_mul_f32 v56, v68, v16
  v_mul_f32 v58, v69, v17
  v_mul_f32 v57, v68, v18
  v_mfma_f32_32x32x16_bf16 v[128:143], a[144:147], a[52:55], v[128:143]
  v_mul_f32 v59, v69, v19
  v_fmac_f32 v56, v84, v18
  v_fmac_f32 v58, v85, v19
  v_fma_f32 v57, v84, v16, -v57
  v_fma_f32 v59, v85, v17, -v59
  v_cvt_pk_bf16_f32 v194, v56, v58
  v_mfma_f32_32x32x16_bf16 v[144:159], a[128:131], a[84:87], v[144:159]
  v_cvt_pk_bf16_f32 v202, v57, v59
  v_mul_f32 v60, v100, v16
  v_mul_f32 v62, v101, v17
  v_mul_f32 v61, v100, v18
  v_mul_f32 v63, v101, v19
  v_mfma_f32_32x32x16_bf16 v[128:143], a[132:135], a[28:31], v[128:143]
  v_fmac_f32 v60, v116, v18
  v_fmac_f32 v62, v117, v19
  v_fma_f32 v61, v116, v16, -v61
  v_fma_f32 v63, v117, v17, -v63
  v_cvt_pk_bf16_f32 v210, v60, v62
  v_cvt_pk_bf16_f32 v218, v61, v63
  v_mfma_f32_32x32x16_bf16 v[144:159], a[148:151], a[28:31], v[144:159]
  ds_read_b128 v[16:19], v2 offset:6144
  s_waitcnt lgkmcnt(3)
  v_mul_f32 v56, v70, v20
  v_mul_f32 v58, v71, v21
  v_mul_f32 v57, v70, v22
  v_mul_f32 v59, v71, v23
  v_mfma_f32_32x32x16_bf16 v[128:143], a[148:151], a[60:63], v[128:143]
  v_fmac_f32 v56, v86, v22
  v_fmac_f32 v58, v87, v23
  v_fma_f32 v57, v86, v20, -v57
  v_fma_f32 v59, v87, v21, -v59
  v_cvt_pk_bf16_f32 v195, v56, v58
  v_mfma_f32_32x32x16_bf16 v[144:159], a[132:135], a[92:95], v[144:159]
  v_cvt_pk_bf16_f32 v203, v57, v59
  v_mul_f32 v60, v102, v20
  v_mul_f32 v62, v103, v21
  v_mul_f32 v61, v102, v22
  v_mul_f32 v63, v103, v23
  v_fmac_f32 v60, v118, v22
  v_mfma_f32_32x32x16_bf16 v[160:175], a[152:155], a[4:7], 0
  v_fmac_f32 v62, v119, v23
  v_fma_f32 v61, v118, v20, -v61
  v_fma_f32 v63, v119, v21, -v63
  v_cvt_pk_bf16_f32 v211, v60, v62
  v_cvt_pk_bf16_f32 v219, v61, v63
  v_mfma_f32_32x32x16_bf16 v[176:191], a[168:171], a[4:7], 0
  ds_read_b128 v[20:23], v2 offset:7168
  s_waitcnt lgkmcnt(3)
  v_mul_f32 v56, v72, v8
  v_mul_f32 v58, v73, v9
  v_mul_f32 v57, v72, v10
  v_mul_f32 v59, v73, v11
  v_fmac_f32 v56, v88, v10
  v_mfma_f32_32x32x16_bf16 v[160:175], a[168:171], a[36:39], v[160:175]
  v_fmac_f32 v58, v89, v11
  v_fma_f32 v57, v88, v8, -v57
  v_fma_f32 v59, v89, v9, -v59
  v_cvt_pk_bf16_f32 v196, v56, v58
  v_cvt_pk_bf16_f32 v204, v57, v59
  v_mfma_f32_32x32x16_bf16 v[176:191], a[152:155], a[68:71], v[176:191]
  v_mul_f32 v60, v104, v8
  v_mul_f32 v62, v105, v9
  v_mul_f32 v61, v104, v10
  v_mul_f32 v63, v105, v11
  v_fmac_f32 v60, v120, v10
  v_mfma_f32_32x32x16_bf16 v[160:175], a[156:159], a[12:15], v[160:175]
  v_fmac_f32 v62, v121, v11
  v_fma_f32 v61, v120, v8, -v61
  v_fma_f32 v63, v121, v9, -v63
  v_cvt_pk_bf16_f32 v212, v60, v62
  v_cvt_pk_bf16_f32 v220, v61, v63
  s_waitcnt lgkmcnt(2)
  v_mul_f32 v56, v74, v12
  v_mfma_f32_32x32x16_bf16 v[176:191], a[172:175], a[12:15], v[176:191]
  v_mul_f32 v58, v75, v13
  v_mul_f32 v57, v74, v14
  v_mul_f32 v59, v75, v15
  v_fmac_f32 v56, v90, v14
  v_fmac_f32 v58, v91, v15
  v_mfma_f32_32x32x16_bf16 v[160:175], a[172:175], a[44:47], v[160:175]
  v_fma_f32 v57, v90, v12, -v57
  v_fma_f32 v59, v91, v13, -v59
  v_cvt_pk_bf16_f32 v197, v56, v58
  v_cvt_pk_bf16_f32 v205, v57, v59
  v_mul_f32 v60, v106, v12
  v_mul_f32 v62, v107, v13
  v_mfma_f32_32x32x16_bf16 v[176:191], a[156:159], a[76:79], v[176:191]
  v_mul_f32 v61, v106, v14
  v_mul_f32 v63, v107, v15
  v_fmac_f32 v60, v122, v14
  v_fmac_f32 v62, v123, v15
  v_fma_f32 v61, v122, v12, -v61
  v_mfma_f32_32x32x16_bf16 v[160:175], a[160:163], a[20:23], v[160:175]
  v_fma_f32 v63, v123, v13, -v63
  v_cvt_pk_bf16_f32 v213, v60, v62
  v_cvt_pk_bf16_f32 v221, v61, v63
  s_waitcnt lgkmcnt(1)
  v_mul_f32 v56, v76, v16
  v_mul_f32 v58, v77, v17
  v_mul_f32 v57, v76, v18
  v_mfma_f32_32x32x16_bf16 v[176:191], a[176:179], a[20:23], v[176:191]
  v_mul_f32 v59, v77, v19
  v_fmac_f32 v56, v92, v18
  v_fmac_f32 v58, v93, v19
  v_fma_f32 v57, v92, v16, -v57
  v_fma_f32 v59, v93, v17, -v59
  v_mfma_f32_32x32x16_bf16 v[160:175], a[176:179], a[52:55], v[160:175]
  v_cvt_pk_bf16_f32 v198, v56, v58
  v_cvt_pk_bf16_f32 v206, v57, v59
  v_mul_f32 v60, v108, v16
  v_mul_f32 v62, v109, v17
  v_mul_f32 v61, v108, v18
  v_mfma_f32_32x32x16_bf16 v[176:191], a[160:163], a[84:87], v[176:191]
  v_mul_f32 v63, v109, v19
  v_fmac_f32 v60, v124, v18
  v_fmac_f32 v62, v125, v19
  v_fma_f32 v61, v124, v16, -v61
  v_fma_f32 v63, v125, v17, -v63
  v_cvt_pk_bf16_f32 v214, v60, v62
  v_mfma_f32_32x32x16_bf16 v[160:175], a[164:167], a[28:31], v[160:175]
  v_cvt_pk_bf16_f32 v222, v61, v63
  s_waitcnt lgkmcnt(0)
  v_mul_f32 v56, v78, v20
  v_mul_f32 v58, v79, v21
  v_mul_f32 v57, v78, v22
  v_mul_f32 v59, v79, v23
  v_mfma_f32_32x32x16_bf16 v[176:191], a[180:183], a[28:31], v[176:191]
  v_fmac_f32 v56, v94, v22
  v_fmac_f32 v58, v95, v23
  v_fma_f32 v57, v94, v20, -v57
  v_fma_f32 v59, v95, v21, -v59
  v_cvt_pk_bf16_f32 v199, v56, v58
  v_cvt_pk_bf16_f32 v207, v57, v59
  v_mfma_f32_32x32x16_bf16 v[160:175], a[180:183], a[60:63], v[160:175]
  v_mul_f32 v60, v110, v20
  v_mul_f32 v62, v111, v21
  v_mul_f32 v61, v110, v22
  v_mul_f32 v63, v111, v23
  v_fmac_f32 v60, v126, v22
  v_mfma_f32_32x32x16_bf16 v[176:191], a[164:167], a[92:95], v[176:191]
  v_fmac_f32 v62, v127, v23
  v_fma_f32 v61, v126, v20, -v61
  v_fma_f32 v63, v127, v21, -v63
  v_cvt_pk_bf16_f32 v215, v60, v62
  v_cvt_pk_bf16_f32 v223, v61, v63
  v_mfma_f32_32x32x16_bf16 v[64:79], a[96:99], v[192:195], 0
  ds_read_b128 v[8:11], v2 offset:8192
  ds_read_b128 v[12:15], v2 offset:9216
  ds_read_b128 v[16:19], v2 offset:10240
  ds_read_b128 v[20:23], v2 offset:11264
  s_waitcnt lgkmcnt(3)
  v_mul_f32 v56, v128, v8
  v_mul_f32 v58, v129, v9
  v_mul_f32 v57, v128, v10
  v_mul_f32 v59, v129, v11
  v_fmac_f32 v56, v144, v10
  v_fmac_f32 v58, v145, v11
  v_fma_f32 v57, v144, v8, -v57
  v_mfma_f32_32x32x16_bf16 v[80:95], a[96:99], v[200:203], 0
  v_fma_f32 v59, v145, v9, -v59
  v_cvt_pk_bf16_f32 v224, v56, v58
  v_cvt_pk_bf16_f32 v232, v57, v59
  v_mul_f32 v60, v160, v8
  v_mul_f32 v62, v161, v9
  v_mul_f32 v61, v160, v10
  v_mul_f32 v63, v161, v11
  v_fmac_f32 v60, v176, v10
  v_fmac_f32 v62, v177, v11
  v_fma_f32 v61, v176, v8, -v61
  v_mfma_f32_32x32x16_bf16 v[64:79], a[100:103], v[200:203], v[64:79]
  v_fma_f32 v63, v177, v9, -v63
  v_cvt_pk_bf16_f32 v240, v60, v62
  v_cvt_pk_bf16_f32 v248, v61, v63
  ds_read_b128 v[8:11], v2 offset:12288
  s_waitcnt lgkmcnt(3)
  v_mul_f32 v56, v130, v12
  v_mul_f32 v58, v131, v13
  v_mul_f32 v57, v130, v14
  v_mul_f32 v59, v131, v15
  v_fmac_f32 v56, v146, v14
  v_fmac_f32 v58, v147, v15
  v_fma_f32 v57, v146, v12, -v57
  v_mfma_f32_32x32x16_bf16 v[80:95], a[104:107], v[192:195], v[80:95]
  v_fma_f32 v59, v147, v13, -v59
  v_cvt_pk_bf16_f32 v225, v56, v58
  v_cvt_pk_bf16_f32 v233, v57, v59
  v_mul_f32 v60, v162, v12
  v_mul_f32 v62, v163, v13
  v_mul_f32 v61, v162, v14
  v_mul_f32 v63, v163, v15
  v_fmac_f32 v60, v178, v14
  v_fmac_f32 v62, v179, v15
  v_fma_f32 v61, v178, v12, -v61
  v_mfma_f32_32x32x16_bf16 v[64:79], a[108:111], v[196:199], v[64:79]
  v_fma_f32 v63, v179, v13, -v63
  v_cvt_pk_bf16_f32 v241, v60, v62
  v_cvt_pk_bf16_f32 v249, v61, v63
  ds_read_b128 v[12:15], v2 offset:13312
  s_waitcnt lgkmcnt(3)
  v_mul_f32 v56, v132, v16
  v_mul_f32 v58, v133, v17
  v_mul_f32 v57, v132, v18
  v_mul_f32 v59, v133, v19
  v_fmac_f32 v56, v148, v18
  v_fmac_f32 v58, v149, v19
  v_fma_f32 v57, v148, v16, -v57
  v_mfma_f32_32x32x16_bf16 v[80:95], a[108:111], v[204:207], v[80:95]
  v_fma_f32 v59, v149, v17, -v59
  v_cvt_pk_bf16_f32 v226, v56, v58
  v_cvt_pk_bf16_f32 v234, v57, v59
  v_mul_f32 v60, v164, v16
  v_mul_f32 v62, v165, v17
  v_mul_f32 v61, v164, v18
  v_mul_f32 v63, v165, v19
  v_fmac_f32 v60, v180, v18
  v_fmac_f32 v62, v181, v19
  v_fma_f32 v61, v180, v16, -v61
  v_mfma_f32_32x32x16_bf16 v[64:79], a[112:115], v[204:207], v[64:79]
  v_fma_f32 v63, v181, v17, -v63
  v_cvt_pk_bf16_f32 v242, v60, v62
  v_cvt_pk_bf16_f32 v250, v61, v63
  ds_read_b128 v[16:19], v2 offset:14336
  s_waitcnt lgkmcnt(3)
  v_mul_f32 v56, v134, v20
  v_mul_f32 v58, v135, v21
  v_mul_f32 v57, v134, v22
  v_mul_f32 v59, v135, v23
  v_fmac_f32 v56, v150, v22
  v_fmac_f32 v58, v151, v23
  v_fma_f32 v57, v150, v20, -v57
  v_mfma_f32_32x32x16_bf16 v[80:95], a[116:119], v[196:199], v[80:95]
  v_fma_f32 v59, v151, v21, -v59
  v_cvt_pk_bf16_f32 v227, v56, v58
  v_cvt_pk_bf16_f32 v235, v57, v59
  v_mul_f32 v60, v166, v20
  v_mul_f32 v62, v167, v21
  v_mul_f32 v61, v166, v22
  v_mul_f32 v63, v167, v23
  v_fmac_f32 v60, v182, v22
  v_fmac_f32 v62, v183, v23
  v_fma_f32 v61, v182, v20, -v61
  v_mfma_f32_32x32x16_bf16 v[96:111], a[96:99], v[208:211], 0
  v_fma_f32 v63, v183, v21, -v63
  v_cvt_pk_bf16_f32 v243, v60, v62
  v_cvt_pk_bf16_f32 v251, v61, v63
  ds_read_b128 v[20:23], v2 offset:15360
  s_waitcnt lgkmcnt(3)
  v_mul_f32 v56, v136, v8
  v_mul_f32 v58, v137, v9
  v_mul_f32 v57, v136, v10
  v_mul_f32 v59, v137, v11
  v_fmac_f32 v56, v152, v10
  v_fmac_f32 v58, v153, v11
  v_fma_f32 v57, v152, v8, -v57
  v_mfma_f32_32x32x16_bf16 v[112:127], a[96:99], v[216:219], 0
  v_fma_f32 v59, v153, v9, -v59
  v_cvt_pk_bf16_f32 v228, v56, v58
  v_cvt_pk_bf16_f32 v236, v57, v59
  v_mul_f32 v60, v168, v8
  v_mul_f32 v62, v169, v9
  v_mul_f32 v61, v168, v10
  v_mul_f32 v63, v169, v11
  v_fmac_f32 v60, v184, v10
  v_fmac_f32 v62, v185, v11
  v_fma_f32 v61, v184, v8, -v61
  v_mfma_f32_32x32x16_bf16 v[96:111], a[100:103], v[216:219], v[96:111]
  v_fma_f32 v63, v185, v9, -v63
  v_cvt_pk_bf16_f32 v244, v60, v62
  v_cvt_pk_bf16_f32 v252, v61, v63
  s_waitcnt lgkmcnt(2)
  v_mul_f32 v56, v138, v12
  v_mul_f32 v58, v139, v13
  v_mul_f32 v57, v138, v14
  v_mul_f32 v59, v139, v15
  v_fmac_f32 v56, v154, v14
  v_fmac_f32 v58, v155, v15
  v_fma_f32 v57, v154, v12, -v57
  v_fma_f32 v59, v155, v13, -v59
  v_mfma_f32_32x32x16_bf16 v[112:127], a[104:107], v[208:211], v[112:127]
  v_cvt_pk_bf16_f32 v229, v56, v58
  v_cvt_pk_bf16_f32 v237, v57, v59
  v_mul_f32 v60, v170, v12
  v_mul_f32 v62, v171, v13
  v_mul_f32 v61, v170, v14
  v_mul_f32 v63, v171, v15
  v_fmac_f32 v60, v186, v14
  v_fmac_f32 v62, v187, v15
  v_fma_f32 v61, v186, v12, -v61
  v_fma_f32 v63, v187, v13, -v63
  v_mfma_f32_32x32x16_bf16 v[96:111], a[108:111], v[212:215], v[96:111]
  v_cvt_pk_bf16_f32 v245, v60, v62
  v_cvt_pk_bf16_f32 v253, v61, v63
  s_waitcnt lgkmcnt(1)
  v_mul_f32 v56, v140, v16
  v_mul_f32 v58, v141, v17
  v_mul_f32 v57, v140, v18
  v_mul_f32 v59, v141, v19
  v_fmac_f32 v56, v156, v18
  v_fmac_f32 v58, v157, v19
  v_fma_f32 v57, v156, v16, -v57
  v_fma_f32 v59, v157, v17, -v59
  v_cvt_pk_bf16_f32 v230, v56, v58
  v_mfma_f32_32x32x16_bf16 v[112:127], a[108:111], v[220:223], v[112:127]
  v_cvt_pk_bf16_f32 v238, v57, v59
  v_mul_f32 v60, v172, v16
  v_mul_f32 v62, v173, v17
  v_mul_f32 v61, v172, v18
  v_mul_f32 v63, v173, v19
  v_fmac_f32 v60, v188, v18
  v_fmac_f32 v62, v189, v19
  v_fma_f32 v61, v188, v16, -v61
  v_fma_f32 v63, v189, v17, -v63
  v_cvt_pk_bf16_f32 v246, v60, v62
  v_mfma_f32_32x32x16_bf16 v[96:111], a[112:115], v[220:223], v[96:111]
  v_cvt_pk_bf16_f32 v254, v61, v63
  s_waitcnt lgkmcnt(0)
  v_mul_f32 v56, v142, v20
  v_mul_f32 v58, v143, v21
  v_mul_f32 v57, v142, v22
  v_mul_f32 v59, v143, v23
  v_fmac_f32 v56, v158, v22
  v_fmac_f32 v58, v159, v23
  v_fma_f32 v57, v158, v20, -v57
  v_fma_f32 v59, v159, v21, -v59
  v_cvt_pk_bf16_f32 v231, v56, v58
  v_cvt_pk_bf16_f32 v239, v57, v59
  v_mfma_f32_32x32x16_bf16 v[112:127], a[116:119], v[212:215], v[112:127]
  v_mul_f32 v60, v174, v20
  v_mul_f32 v62, v175, v21
  v_mul_f32 v61, v174, v22
  v_mul_f32 v63, v175, v23
  v_fmac_f32 v60, v190, v22
  v_fmac_f32 v62, v191, v23
  v_fma_f32 v61, v190, v20, -v61
  v_fma_f32 v63, v191, v21, -v63
  v_cvt_pk_bf16_f32 v247, v60, v62
  v_cvt_pk_bf16_f32 v255, v61, v63
  v_mfma_f32_32x32x16_bf16 v[128:143], a[96:99], v[224:227], 0
  s_waitcnt vmcnt(15)
  v_lshlrev_b32 v8, 16, v24
  v_and_b32 v9, 0xffff0000, v24
  v_lshlrev_b32 v10, 16, v25
  v_and_b32 v11, 0xffff0000, v25
  v_mul_f32 v56, v80, v9
  v_mul_f32 v58, v81, v11
  v_mul_f32 v57, v80, v8
  v_mul_f32 v59, v81, v10
  v_fma_f32 v56, v64, v8, -v56
  v_fma_f32 v58, v65, v10, -v58
  v_fmac_f32 v57, v64, v9
  v_fmac_f32 v59, v65, v11
  v_cvt_pk_bf16_f32 v192, v56, v58
  v_cvt_pk_bf16_f32 v200, v57, v59
  v_mfma_f32_32x32x16_bf16 v[144:159], a[96:99], v[232:235], 0
  v_lshlrev_b32 v12, 16, v26
  v_and_b32 v13, 0xffff0000, v26
  v_lshlrev_b32 v14, 16, v27
  v_and_b32 v15, 0xffff0000, v27
  v_mul_f32 v60, v82, v13
  v_mul_f32 v62, v83, v15
  v_mul_f32 v61, v82, v12
  v_mul_f32 v63, v83, v14
  v_fma_f32 v60, v66, v12, -v60
  v_fma_f32 v62, v67, v14, -v62
  v_fmac_f32 v61, v66, v13
  v_fmac_f32 v63, v67, v15
  v_cvt_pk_bf16_f32 v193, v60, v62
  v_cvt_pk_bf16_f32 v201, v61, v63
  v_mfma_f32_32x32x16_bf16 v[128:143], a[100:103], v[232:235], v[128:143]
  s_waitcnt vmcnt(14)
  v_lshlrev_b32 v8, 16, v28
  v_and_b32 v9, 0xffff0000, v28
  v_lshlrev_b32 v10, 16, v29
  v_and_b32 v11, 0xffff0000, v29
  v_mul_f32 v56, v84, v9
  v_mul_f32 v58, v85, v11
  v_mul_f32 v57, v84, v8
  v_mul_f32 v59, v85, v10
  v_fma_f32 v56, v68, v8, -v56
  v_fma_f32 v58, v69, v10, -v58
  v_fmac_f32 v57, v68, v9
  v_fmac_f32 v59, v69, v11
  v_cvt_pk_bf16_f32 v194, v56, v58
  v_cvt_pk_bf16_f32 v202, v57, v59
  v_mfma_f32_32x32x16_bf16 v[144:159], a[104:107], v[224:227], v[144:159]
  v_lshlrev_b32 v12, 16, v30
  v_and_b32 v13, 0xffff0000, v30
  v_lshlrev_b32 v14, 16, v31
  v_and_b32 v15, 0xffff0000, v31
  v_mul_f32 v60, v86, v13
  v_mul_f32 v62, v87, v15
  v_mul_f32 v61, v86, v12
  v_mul_f32 v63, v87, v14
  v_fma_f32 v60, v70, v12, -v60
  v_fma_f32 v62, v71, v14, -v62
  v_fmac_f32 v61, v70, v13
  v_fmac_f32 v63, v71, v15
  v_cvt_pk_bf16_f32 v195, v60, v62
  v_cvt_pk_bf16_f32 v203, v61, v63
  v_mfma_f32_32x32x16_bf16 v[128:143], a[108:111], v[228:231], v[128:143]
  s_waitcnt vmcnt(13)
  v_lshlrev_b32 v8, 16, v32
  v_and_b32 v9, 0xffff0000, v32
  v_lshlrev_b32 v10, 16, v33
  v_and_b32 v11, 0xffff0000, v33
  v_mul_f32 v56, v88, v9
  v_mul_f32 v58, v89, v11
  v_mul_f32 v57, v88, v8
  v_mul_f32 v59, v89, v10
  v_fma_f32 v56, v72, v8, -v56
  v_fma_f32 v58, v73, v10, -v58
  v_fmac_f32 v57, v72, v9
  v_fmac_f32 v59, v73, v11
  v_cvt_pk_bf16_f32 v196, v56, v58
  v_cvt_pk_bf16_f32 v204, v57, v59
  v_mfma_f32_32x32x16_bf16 v[144:159], a[108:111], v[236:239], v[144:159]
  v_lshlrev_b32 v12, 16, v34
  v_and_b32 v13, 0xffff0000, v34
  v_lshlrev_b32 v14, 16, v35
  v_and_b32 v15, 0xffff0000, v35
  v_mul_f32 v60, v90, v13
  v_mul_f32 v62, v91, v15
  v_mul_f32 v61, v90, v12
  v_mul_f32 v63, v91, v14
  v_fma_f32 v60, v74, v12, -v60
  v_fma_f32 v62, v75, v14, -v62
  v_fmac_f32 v61, v74, v13
  v_fmac_f32 v63, v75, v15
  v_cvt_pk_bf16_f32 v197, v60, v62
  v_cvt_pk_bf16_f32 v205, v61, v63
  v_mfma_f32_32x32x16_bf16 v[128:143], a[112:115], v[236:239], v[128:143]
  s_waitcnt vmcnt(12)
  v_lshlrev_b32 v8, 16, v36
  v_and_b32 v9, 0xffff0000, v36
  v_lshlrev_b32 v10, 16, v37
  v_and_b32 v11, 0xffff0000, v37
  v_mul_f32 v56, v92, v9
  v_mul_f32 v58, v93, v11
  v_mul_f32 v57, v92, v8
  v_mul_f32 v59, v93, v10
  v_fma_f32 v56, v76, v8, -v56
  v_fma_f32 v58, v77, v10, -v58
  v_fmac_f32 v57, v76, v9
  v_fmac_f32 v59, v77, v11
  v_cvt_pk_bf16_f32 v198, v56, v58
  v_cvt_pk_bf16_f32 v206, v57, v59
  v_mfma_f32_32x32x16_bf16 v[144:159], a[116:119], v[228:231], v[144:159]
  v_lshlrev_b32 v12, 16, v38
  v_and_b32 v13, 0xffff0000, v38
  v_lshlrev_b32 v14, 16, v39
  v_and_b32 v15, 0xffff0000, v39
  v_mul_f32 v60, v94, v13
  v_mul_f32 v62, v95, v15
  v_mul_f32 v61, v94, v12
  v_mul_f32 v63, v95, v14
  v_fma_f32 v60, v78, v12, -v60
  v_fma_f32 v62, v79, v14, -v62
  v_fmac_f32 v61, v78, v13
  v_fmac_f32 v63, v79, v15
  v_cvt_pk_bf16_f32 v199, v60, v62
  v_cvt_pk_bf16_f32 v207, v61, v63
  v_mfma_f32_32x32x16_bf16 v[160:175], a[96:99], v[240:243], 0
  s_waitcnt vmcnt(11)
  v_lshlrev_b32 v8, 16, v40
  v_and_b32 v9, 0xffff0000, v40
  v_lshlrev_b32 v10, 16, v41
  v_and_b32 v11, 0xffff0000, v41
  v_mul_f32 v56, v112, v9
  v_mul_f32 v58, v113, v11
  v_mul_f32 v57, v112, v8
  v_mul_f32 v59, v113, v10
  v_fma_f32 v56, v96, v8, -v56
  v_fma_f32 v58, v97, v10, -v58
  v_fmac_f32 v57, v96, v9
  v_fmac_f32 v59, v97, v11
  v_cvt_pk_bf16_f32 v208, v56, v58
  v_cvt_pk_bf16_f32 v216, v57, v59
  v_mfma_f32_32x32x16_bf16 v[176:191], a[96:99], v[248:251], 0
  v_lshlrev_b32 v12, 16, v42
  v_and_b32 v13, 0xffff0000, v42
  v_lshlrev_b32 v14, 16, v43
  v_and_b32 v15, 0xffff0000, v43
  v_mul_f32 v60, v114, v13
  v_mul_f32 v62, v115, v15
  v_mul_f32 v61, v114, v12
  v_mul_f32 v63, v115, v14
  v_fma_f32 v60, v98, v12, -v60
  v_fma_f32 v62, v99, v14, -v62
  v_fmac_f32 v61, v98, v13
  v_fmac_f32 v63, v99, v15
  v_cvt_pk_bf16_f32 v209, v60, v62
  v_cvt_pk_bf16_f32 v217, v61, v63
  v_mfma_f32_32x32x16_bf16 v[160:175], a[100:103], v[248:251], v[160:175]
  s_waitcnt vmcnt(10)
  v_lshlrev_b32 v8, 16, v44
  v_and_b32 v9, 0xffff0000, v44
  v_lshlrev_b32 v10, 16, v45
  v_and_b32 v11, 0xffff0000, v45
  v_mul_f32 v56, v116, v9
  v_mul_f32 v58, v117, v11
  v_mul_f32 v57, v116, v8
  v_mul_f32 v59, v117, v10
  v_fma_f32 v56, v100, v8, -v56
  v_fma_f32 v58, v101, v10, -v58
  v_fmac_f32 v57, v100, v9
  v_fmac_f32 v59, v101, v11
  v_cvt_pk_bf16_f32 v210, v56, v58
  v_cvt_pk_bf16_f32 v218, v57, v59
  v_mfma_f32_32x32x16_bf16 v[176:191], a[104:107], v[240:243], v[176:191]
  v_lshlrev_b32 v12, 16, v46
  v_and_b32 v13, 0xffff0000, v46
  v_lshlrev_b32 v14, 16, v47
  v_and_b32 v15, 0xffff0000, v47
  v_mul_f32 v60, v118, v13
  v_mul_f32 v62, v119, v15
  v_mul_f32 v61, v118, v12
  v_mul_f32 v63, v119, v14
  v_fma_f32 v60, v102, v12, -v60
  v_fma_f32 v62, v103, v14, -v62
  v_fmac_f32 v61, v102, v13
  v_fmac_f32 v63, v103, v15
  v_cvt_pk_bf16_f32 v211, v60, v62
  v_cvt_pk_bf16_f32 v219, v61, v63
  v_mfma_f32_32x32x16_bf16 v[160:175], a[108:111], v[244:247], v[160:175]
  s_waitcnt vmcnt(9)
  v_lshlrev_b32 v8, 16, v48
  v_and_b32 v9, 0xffff0000, v48
  v_lshlrev_b32 v10, 16, v49
  v_and_b32 v11, 0xffff0000, v49
  v_mul_f32 v56, v120, v9
  v_mul_f32 v58, v121, v11
  v_mul_f32 v57, v120, v8
  v_mul_f32 v59, v121, v10
  v_fma_f32 v56, v104, v8, -v56
  v_fma_f32 v58, v105, v10, -v58
  v_fmac_f32 v57, v104, v9
  v_fmac_f32 v59, v105, v11
  v_cvt_pk_bf16_f32 v212, v56, v58
  v_cvt_pk_bf16_f32 v220, v57, v59
  v_mfma_f32_32x32x16_bf16 v[176:191], a[108:111], v[252:255], v[176:191]
  v_lshlrev_b32 v12, 16, v50
  v_and_b32 v13, 0xffff0000, v50
  v_lshlrev_b32 v14, 16, v51
  v_and_b32 v15, 0xffff0000, v51
  v_mul_f32 v60, v122, v13
  v_mul_f32 v62, v123, v15
  v_mul_f32 v61, v122, v12
  v_mul_f32 v63, v123, v14
  v_fma_f32 v60, v106, v12, -v60
  v_fma_f32 v62, v107, v14, -v62
  v_fmac_f32 v61, v106, v13
  v_fmac_f32 v63, v107, v15
  v_cvt_pk_bf16_f32 v213, v60, v62
  v_cvt_pk_bf16_f32 v221, v61, v63
  v_mfma_f32_32x32x16_bf16 v[160:175], a[112:115], v[252:255], v[160:175]
  s_waitcnt vmcnt(8)
  v_lshlrev_b32 v8, 16, v52
  v_and_b32 v9, 0xffff0000, v52
  v_lshlrev_b32 v10, 16, v53
  v_and_b32 v11, 0xffff0000, v53
  v_mul_f32 v56, v124, v9
  v_mul_f32 v58, v125, v11
  v_mul_f32 v57, v124, v8
  v_mul_f32 v59, v125, v10
  v_fma_f32 v56, v108, v8, -v56
  v_fma_f32 v58, v109, v10, -v58
  v_fmac_f32 v57, v108, v9
  v_fmac_f32 v59, v109, v11
  v_cvt_pk_bf16_f32 v214, v56, v58
  v_cvt_pk_bf16_f32 v222, v57, v59
  v_mfma_f32_32x32x16_bf16 v[176:191], a[116:119], v[244:247], v[176:191]
  v_lshlrev_b32 v12, 16, v54
  v_and_b32 v13, 0xffff0000, v54
  v_lshlrev_b32 v14, 16, v55
  v_and_b32 v15, 0xffff0000, v55
  v_mul_f32 v60, v126, v13
  v_mul_f32 v62, v127, v15
  v_mul_f32 v61, v126, v12
  v_mul_f32 v63, v127, v14
  v_fma_f32 v60, v110, v12, -v60
  v_fma_f32 v62, v111, v14, -v62
  v_fmac_f32 v61, v110, v13
  v_fmac_f32 v63, v111, v15
  v_cvt_pk_bf16_f32 v215, v60, v62
  v_cvt_pk_bf16_f32 v223, v61, v63
  v_mfma_f32_32x32x16_bf16 v[64:79], v[192:195], a[96:99], 0
  s_waitcnt vmcnt(7)
  v_accvgpr_read_b32 v16, a184
  v_accvgpr_read_b32 v17, a185
  v_lshlrev_b32 v8, 16, v16
  v_and_b32 v9, 0xffff0000, v16
  v_lshlrev_b32 v10, 16, v17
  v_and_b32 v11, 0xffff0000, v17
  v_mul_f32 v56, v144, v9
  v_mul_f32 v58, v145, v11
  v_mul_f32 v57, v144, v8
  v_mul_f32 v59, v145, v10
  v_fma_f32 v56, v128, v8, -v56
  v_fma_f32 v58, v129, v10, -v58
  v_fmac_f32 v57, v128, v9
  v_fmac_f32 v59, v129, v11
  v_cvt_pk_bf16_f32 v224, v56, v58
  v_cvt_pk_bf16_f32 v232, v57, v59
  v_mfma_f32_32x32x16_bf16 v[80:95], v[200:203], a[96:99], 0
  v_accvgpr_read_b32 v18, a186
  v_accvgpr_read_b32 v19, a187
  v_lshlrev_b32 v12, 16, v18
  v_and_b32 v13, 0xffff0000, v18
  v_lshlrev_b32 v14, 16, v19
  v_and_b32 v15, 0xffff0000, v19
  v_mul_f32 v60, v146, v13
  v_mul_f32 v62, v147, v15
  v_mul_f32 v61, v146, v12
  v_mul_f32 v63, v147, v14
  v_fma_f32 v60, v130, v12, -v60
  v_fma_f32 v62, v131, v14, -v62
  v_fmac_f32 v61, v130, v13
  v_fmac_f32 v63, v131, v15
  v_cvt_pk_bf16_f32 v225, v60, v62
  v_cvt_pk_bf16_f32 v233, v61, v63
  v_mfma_f32_32x32x16_bf16 v[64:79], v[200:203], a[104:107], v[64:79]
  s_waitcnt vmcnt(6)
  v_accvgpr_read_b32 v16, a188
  v_accvgpr_read_b32 v17, a189
  v_lshlrev_b32 v8, 16, v16
  v_and_b32 v9, 0xffff0000, v16
  v_lshlrev_b32 v10, 16, v17
  v_and_b32 v11, 0xffff0000, v17
  v_mul_f32 v56, v148, v9
  v_mul_f32 v58, v149, v11
  v_mul_f32 v57, v148, v8
  v_mul_f32 v59, v149, v10
  v_fma_f32 v56, v132, v8, -v56
  v_fma_f32 v58, v133, v10, -v58
  v_fmac_f32 v57, v132, v9
  v_fmac_f32 v59, v133, v11
  v_cvt_pk_bf16_f32 v226, v56, v58
  v_cvt_pk_bf16_f32 v234, v57, v59
  v_mfma_f32_32x32x16_bf16 v[80:95], v[192:195], a[100:103], v[80:95]
  v_accvgpr_read_b32 v18, a190
  v_accvgpr_read_b32 v19, a191
  v_lshlrev_b32 v12, 16, v18
  v_and_b32 v13, 0xffff0000, v18
  v_lshlrev_b32 v14, 16, v19
  v_and_b32 v15, 0xffff0000, v19
  v_mul_f32 v60, v150, v13
  v_mul_f32 v62, v151, v15
  v_mul_f32 v61, v150, v12
  v_mul_f32 v63, v151, v14
  v_fma_f32 v60, v134, v12, -v60
  v_fma_f32 v62, v135, v14, -v62
  v_fmac_f32 v61, v134, v13
  v_fmac_f32 v63, v135, v15
  v_cvt_pk_bf16_f32 v227, v60, v62
  v_cvt_pk_bf16_f32 v235, v61, v63
  v_mfma_f32_32x32x16_bf16 v[64:79], v[196:199], a[108:111], v[64:79]
  s_waitcnt vmcnt(5)
  v_accvgpr_read_b32 v16, a192
  v_accvgpr_read_b32 v17, a193
  v_lshlrev_b32 v8, 16, v16
  v_and_b32 v9, 0xffff0000, v16
  v_lshlrev_b32 v10, 16, v17
  v_and_b32 v11, 0xffff0000, v17
  v_mul_f32 v56, v152, v9
  v_mul_f32 v58, v153, v11
  v_mul_f32 v57, v152, v8
  v_mul_f32 v59, v153, v10
  v_fma_f32 v56, v136, v8, -v56
  v_fma_f32 v58, v137, v10, -v58
  v_fmac_f32 v57, v136, v9
  v_fmac_f32 v59, v137, v11
  v_cvt_pk_bf16_f32 v228, v56, v58
  v_cvt_pk_bf16_f32 v236, v57, v59
  v_mfma_f32_32x32x16_bf16 v[80:95], v[204:207], a[108:111], v[80:95]
  v_accvgpr_read_b32 v18, a194
  v_accvgpr_read_b32 v19, a195
  v_lshlrev_b32 v12, 16, v18
  v_and_b32 v13, 0xffff0000, v18
  v_lshlrev_b32 v14, 16, v19
  v_and_b32 v15, 0xffff0000, v19
  v_mul_f32 v60, v154, v13
  v_mul_f32 v62, v155, v15
  v_mul_f32 v61, v154, v12
  v_mul_f32 v63, v155, v14
  v_fma_f32 v60, v138, v12, -v60
  v_fma_f32 v62, v139, v14, -v62
  v_fmac_f32 v61, v138, v13
  v_fmac_f32 v63, v139, v15
  v_cvt_pk_bf16_f32 v229, v60, v62
  v_cvt_pk_bf16_f32 v237, v61, v63
  v_mfma_f32_32x32x16_bf16 v[64:79], v[204:207], a[116:119], v[64:79]
  s_waitcnt vmcnt(4)
  v_accvgpr_read_b32 v16, a196
  v_accvgpr_read_b32 v17, a197
  v_lshlrev_b32 v8, 16, v16
  v_and_b32 v9, 0xffff0000, v16
  v_lshlrev_b32 v10, 16, v17
  v_and_b32 v11, 0xffff0000, v17
  v_mul_f32 v56, v156, v9
  v_mul_f32 v58, v157, v11
  v_mul_f32 v57, v156, v8
  v_mul_f32 v59, v157, v10
  v_fma_f32 v56, v140, v8, -v56
  v_fma_f32 v58, v141, v10, -v58
  v_fmac_f32 v57, v140, v9
  v_fmac_f32 v59, v141, v11
  v_cvt_pk_bf16_f32 v230, v56, v58
  v_cvt_pk_bf16_f32 v238, v57, v59
  v_mfma_f32_32x32x16_bf16 v[80:95], v[196:199], a[112:115], v[80:95]
  v_accvgpr_read_b32 v18, a198
  v_accvgpr_read_b32 v19, a199
  v_lshlrev_b32 v12, 16, v18
  v_and_b32 v13, 0xffff0000, v18
  v_lshlrev_b32 v14, 16, v19
  v_and_b32 v15, 0xffff0000, v19
  v_mul_f32 v60, v158, v13
  v_mul_f32 v62, v159, v15
  v_mul_f32 v61, v158, v12
  v_mul_f32 v63, v159, v14
  v_fma_f32 v60, v142, v12, -v60
  v_fma_f32 v62, v143, v14, -v62
  v_fmac_f32 v61, v142, v13
  v_fmac_f32 v63, v143, v15
  v_cvt_pk_bf16_f32 v231, v60, v62
  v_cvt_pk_bf16_f32 v239, v61, v63
  v_mfma_f32_32x32x16_bf16 v[96:111], v[208:211], a[96:99], 0
  s_waitcnt vmcnt(3)
  v_accvgpr_read_b32 v16, a200
  v_accvgpr_read_b32 v17, a201
  v_lshlrev_b32 v8, 16, v16
  v_and_b32 v9, 0xffff0000, v16
  v_lshlrev_b32 v10, 16, v17
  v_and_b32 v11, 0xffff0000, v17
  v_mul_f32 v56, v176, v9
  v_mul_f32 v58, v177, v11
  v_mul_f32 v57, v176, v8
  v_mul_f32 v59, v177, v10
  v_fma_f32 v56, v160, v8, -v56
  v_fma_f32 v58, v161, v10, -v58
  v_fmac_f32 v57, v160, v9
  v_fmac_f32 v59, v161, v11
  v_cvt_pk_bf16_f32 v240, v56, v58
  v_cvt_pk_bf16_f32 v248, v57, v59
  v_mfma_f32_32x32x16_bf16 v[112:127], v[216:219], a[96:99], 0
  v_accvgpr_read_b32 v18, a202
  v_accvgpr_read_b32 v19, a203
  v_lshlrev_b32 v12, 16, v18
  v_and_b32 v13, 0xffff0000, v18
  v_lshlrev_b32 v14, 16, v19
  v_and_b32 v15, 0xffff0000, v19
  v_mul_f32 v60, v178, v13
  v_mul_f32 v62, v179, v15
  v_mul_f32 v61, v178, v12
  v_mul_f32 v63, v179, v14
  v_fma_f32 v60, v162, v12, -v60
  v_fma_f32 v62, v163, v14, -v62
  v_fmac_f32 v61, v162, v13
  v_fmac_f32 v63, v163, v15
  v_cvt_pk_bf16_f32 v241, v60, v62
  v_cvt_pk_bf16_f32 v249, v61, v63
  v_mfma_f32_32x32x16_bf16 v[96:111], v[216:219], a[104:107], v[96:111]
  s_waitcnt vmcnt(2)
  v_accvgpr_read_b32 v16, a204
  v_accvgpr_read_b32 v17, a205
  v_lshlrev_b32 v8, 16, v16
  v_and_b32 v9, 0xffff0000, v16
  v_lshlrev_b32 v10, 16, v17
  v_and_b32 v11, 0xffff0000, v17
  v_mul_f32 v56, v180, v9
  v_mul_f32 v58, v181, v11
  v_mul_f32 v57, v180, v8
  v_mul_f32 v59, v181, v10
  v_fma_f32 v56, v164, v8, -v56
  v_fma_f32 v58, v165, v10, -v58
  v_fmac_f32 v57, v164, v9
  v_fmac_f32 v59, v165, v11
  v_cvt_pk_bf16_f32 v242, v56, v58
  v_cvt_pk_bf16_f32 v250, v57, v59
  v_mfma_f32_32x32x16_bf16 v[112:127], v[208:211], a[100:103], v[112:127]
  v_accvgpr_read_b32 v18, a206
  v_accvgpr_read_b32 v19, a207
  v_lshlrev_b32 v12, 16, v18
  v_and_b32 v13, 0xffff0000, v18
  v_lshlrev_b32 v14, 16, v19
  v_and_b32 v15, 0xffff0000, v19
  v_mul_f32 v60, v182, v13
  v_mul_f32 v62, v183, v15
  v_mul_f32 v61, v182, v12
  v_mul_f32 v63, v183, v14
  v_fma_f32 v60, v166, v12, -v60
  v_fma_f32 v62, v167, v14, -v62
  v_fmac_f32 v61, v166, v13
  v_fmac_f32 v63, v167, v15
  v_cvt_pk_bf16_f32 v243, v60, v62
  v_cvt_pk_bf16_f32 v251, v61, v63
  v_mfma_f32_32x32x16_bf16 v[96:111], v[212:215], a[108:111], v[96:111]
  s_waitcnt vmcnt(1)
  v_accvgpr_read_b32 v16, a208
  v_accvgpr_read_b32 v17, a209
  v_lshlrev_b32 v8, 16, v16
  v_and_b32 v9, 0xffff0000, v16
  v_lshlrev_b32 v10, 16, v17
  v_and_b32 v11, 0xffff0000, v17
  v_mul_f32 v56, v184, v9
  v_mul_f32 v58, v185, v11
  v_mul_f32 v57, v184, v8
  v_mul_f32 v59, v185, v10
  v_fma_f32 v56, v168, v8, -v56
  v_fma_f32 v58, v169, v10, -v58
  v_fmac_f32 v57, v168, v9
  v_fmac_f32 v59, v169, v11
  v_cvt_pk_bf16_f32 v244, v56, v58
  v_cvt_pk_bf16_f32 v252, v57, v59
  v_mfma_f32_32x32x16_bf16 v[112:127], v[220:223], a[108:111], v[112:127]
  v_accvgpr_read_b32 v18, a210
  v_accvgpr_read_b32 v19, a211
  v_lshlrev_b32 v12, 16, v18
  v_and_b32 v13, 0xffff0000, v18
  v_lshlrev_b32 v14, 16, v19
  v_and_b32 v15, 0xffff0000, v19
  v_mul_f32 v60, v186, v13
  v_mul_f32 v62, v187, v15
  v_mul_f32 v61, v186, v12
  v_mul_f32 v63, v187, v14
  v_fma_f32 v60, v170, v12, -v60
  v_fma_f32 v62, v171, v14, -v62
  v_fmac_f32 v61, v170, v13
  v_fmac_f32 v63, v171, v15
  v_cvt_pk_bf16_f32 v245, v60, v62
  v_cvt_pk_bf16_f32 v253, v61, v63
  v_mfma_f32_32x32x16_bf16 v[96:111], v[220:223], a[116:119], v[96:111]
  s_waitcnt vmcnt(0)
  v_accvgpr_read_b32 v16, a212
  v_accvgpr_read_b32 v17, a213
  v_lshlrev_b32 v8, 16, v16
  v_and_b32 v9, 0xffff0000, v16
  v_lshlrev_b32 v10, 16, v17
  v_and_b32 v11, 0xffff0000, v17
  v_mul_f32 v56, v188, v9
  v_mul_f32 v58, v189, v11
  v_mul_f32 v57, v188, v8
  v_mul_f32 v59, v189, v10
  v_fma_f32 v56, v172, v8, -v56
  v_fma_f32 v58, v173, v10, -v58
  v_fmac_f32 v57, v172, v9
  v_fmac_f32 v59, v173, v11
  v_cvt_pk_bf16_f32 v246, v56, v58
  v_cvt_pk_bf16_f32 v254, v57, v59
  v_mfma_f32_32x32x16_bf16 v[112:127], v[212:215], a[112:115], v[112:127]
  v_accvgpr_read_b32 v18, a214
  v_accvgpr_read_b32 v19, a215
  v_lshlrev_b32 v12, 16, v18
  v_and_b32 v13, 0xffff0000, v18
  v_lshlrev_b32 v14, 16, v19
  v_and_b32 v15, 0xffff0000, v19
  v_mul_f32 v60, v190, v13
  v_mul_f32 v62, v191, v15
  v_mul_f32 v61, v190, v12
  v_mul_f32 v63, v191, v14
  v_fma_f32 v60, v174, v12, -v60
  v_fma_f32 v62, v175, v14, -v62
  v_fmac_f32 v61, v174, v13
  v_fmac_f32 v63, v175, v15
  v_cvt_pk_bf16_f32 v247, v60, v62
  v_cvt_pk_bf16_f32 v255, v61, v63
  v_mfma_f32_32x32x16_bf16 v[128:143], v[224:227], a[96:99], 0
  ds_read_b128 v[8:11], v2 offset:16384
  ds_read_b128 v[12:15], v2 offset:17408
  ds_read_b128 v[16:19], v2 offset:18432
  ds_read_b128 v[20:23], v2 offset:19456
  s_waitcnt lgkmcnt(3)
  v_mul_f32 v56, v80, v10
  v_mul_f32 v58, v81, v11
  v_mul_f32 v57, v80, v8
  v_mul_f32 v59, v81, v9
  v_fma_f32 v56, v64, v8, -v56
  v_fma_f32 v58, v65, v9, -v58
  v_fmac_f32 v57, v64, v10
  v_mfma_f32_32x32x16_bf16 v[144:159], v[232:235], a[96:99], 0
  v_fmac_f32 v59, v65, v11
  v_cvt_pk_bf16_f32 v192, v56, v58
  v_cvt_pk_bf16_f32 v200, v57, v59
  v_mul_f32 v60, v112, v10
  v_mul_f32 v62, v113, v11
  v_mul_f32 v61, v112, v8
  v_mul_f32 v63, v113, v9
  v_fma_f32 v60, v96, v8, -v60
  v_fma_f32 v62, v97, v9, -v62
  v_fmac_f32 v61, v96, v10
  v_mfma_f32_32x32x16_bf16 v[128:143], v[232:235], a[104:107], v[128:143]
  v_fmac_f32 v63, v97, v11
  v_cvt_pk_bf16_f32 v208, v60, v62
  v_cvt_pk_bf16_f32 v216, v61, v63
  ds_read_b128 v[8:11], v2 offset:20480
  s_waitcnt lgkmcnt(3)
  v_mul_f32 v56, v82, v14
  v_mul_f32 v58, v83, v15
  v_mul_f32 v57, v82, v12
  v_mul_f32 v59, v83, v13
  v_fma_f32 v56, v66, v12, -v56
  v_fma_f32 v58, v67, v13, -v58
  v_fmac_f32 v57, v66, v14
  v_mfma_f32_32x32x16_bf16 v[144:159], v[224:227], a[100:103], v[144:159]
  v_fmac_f32 v59, v67, v15
  v_cvt_pk_bf16_f32 v193, v56, v58
  v_cvt_pk_bf16_f32 v201, v57, v59
  v_mul_f32 v60, v114, v14
  v_mul_f32 v62, v115, v15
  v_mul_f32 v61, v114, v12
  v_mul_f32 v63, v115, v13
  v_fma_f32 v60, v98, v12, -v60
  v_fma_f32 v62, v99, v13, -v62
  v_fmac_f32 v61, v98, v14
  v_mfma_f32_32x32x16_bf16 v[128:143], v[228:231], a[108:111], v[128:143]
  v_fmac_f32 v63, v99, v15
  v_cvt_pk_bf16_f32 v209, v60, v62
  v_cvt_pk_bf16_f32 v217, v61, v63
  ds_read_b128 v[12:15], v2 offset:21504
  s_waitcnt lgkmcnt(3)
  v_mul_f32 v56, v84, v18
  v_mul_f32 v58, v85, v19
  v_mul_f32 v57, v84, v16
  v_mul_f32 v59, v85, v17
  v_fma_f32 v56, v68, v16, -v56
  v_fma_f32 v58, v69, v17, -v58
  v_fmac_f32 v57, v68, v18
  v_mfma_f32_32x32x16_bf16 v[144:159], v[236:239], a[108:111], v[144:159]
  v_fmac_f32 v59, v69, v19
  v_cvt_pk_bf16_f32 v194, v56, v58
  v_cvt_pk_bf16_f32 v202, v57, v59
  v_mul_f32 v60, v116, v18
  v_mul_f32 v62, v117, v19
  v_mul_f32 v61, v116, v16
  v_mul_f32 v63, v117, v17
  v_fma_f32 v60, v100, v16, -v60
  v_fma_f32 v62, v101, v17, -v62
  v_fmac_f32 v61, v100, v18
  v_mfma_f32_32x32x16_bf16 v[128:143], v[236:239], a[116:119], v[128:143]
  v_fmac_f32 v63, v101, v19
  v_cvt_pk_bf16_f32 v210, v60, v62
  v_cvt_pk_bf16_f32 v218, v61, v63
  ds_read_b128 v[16:19], v2 offset:22528
  s_waitcnt lgkmcnt(3)
  v_mul_f32 v56, v86, v22
  v_mul_f32 v58, v87, v23
  v_mul_f32 v57, v86, v20
  v_mul_f32 v59, v87, v21
  v_fma_f32 v56, v70, v20, -v56
  v_fma_f32 v58, v71, v21, -v58
  v_fmac_f32 v57, v70, v22
  v_mfma_f32_32x32x16_bf16 v[144:159], v[228:231], a[112:115], v[144:159]
  v_fmac_f32 v59, v71, v23
  v_cvt_pk_bf16_f32 v195, v56, v58
  v_cvt_pk_bf16_f32 v203, v57, v59
  v_mul_f32 v60, v118, v22
  v_mul_f32 v62, v119, v23
  v_mul_f32 v61, v118, v20
  v_mul_f32 v63, v119, v21
  v_fma_f32 v60, v102, v20, -v60
  v_fma_f32 v62, v103, v21, -v62
  v_fmac_f32 v61, v102, v22
  v_mfma_f32_32x32x16_bf16 v[160:175], v[240:243], a[96:99], 0
  v_fmac_f32 v63, v103, v23
  v_cvt_pk_bf16_f32 v211, v60, v62
  v_cvt_pk_bf16_f32 v219, v61, v63
  ds_read_b128 v[20:23], v2 offset:23552
  s_waitcnt lgkmcnt(3)
  v_mul_f32 v56, v88, v10
  v_mul_f32 v58, v89, v11
  v_mul_f32 v57, v88, v8
  v_mul_f32 v59, v89, v9
  v_fma_f32 v56, v72, v8, -v56
  v_fma_f32 v58, v73, v9, -v58
  v_fmac_f32 v57, v72, v10
  v_mfma_f32_32x32x16_bf16 v[176:191], v[248:251], a[96:99], 0
  v_fmac_f32 v59, v73, v11
  v_cvt_pk_bf16_f32 v196, v56, v58
  v_cvt_pk_bf16_f32 v204, v57, v59
  v_mul_f32 v60, v120, v10
  v_mul_f32 v62, v121, v11
  v_mul_f32 v61, v120, v8
  v_mul_f32 v63, v121, v9
  v_fma_f32 v60, v104, v8, -v60
  v_fma_f32 v62, v105, v9, -v62
  v_fmac_f32 v61, v104, v10
  v_mfma_f32_32x32x16_bf16 v[160:175], v[248:251], a[104:107], v[160:175]
  v_fmac_f32 v63, v105, v11
  v_cvt_pk_bf16_f32 v212, v60, v62
  v_cvt_pk_bf16_f32 v220, v61, v63
  s_waitcnt lgkmcnt(2)
  v_mul_f32 v56, v90, v14
  v_mul_f32 v58, v91, v15
  v_mul_f32 v57, v90, v12
  v_mul_f32 v59, v91, v13
  v_fma_f32 v56, v74, v12, -v56
  v_fma_f32 v58, v75, v13, -v58
  v_fmac_f32 v57, v74, v14
  v_fmac_f32 v59, v75, v15
  v_mfma_f32_32x32x16_bf16 v[176:191], v[240:243], a[100:103], v[176:191]
  v_cvt_pk_bf16_f32 v197, v56, v58
  v_cvt_pk_bf16_f32 v205, v57, v59
  v_mul_f32 v60, v122, v14
  v_mul_f32 v62, v123, v15
  v_mul_f32 v61, v122, v12
  v_mul_f32 v63, v123, v13
  v_fma_f32 v60, v106, v12, -v60
  v_fma_f32 v62, v107, v13, -v62
  v_fmac_f32 v61, v106, v14
  v_fmac_f32 v63, v107, v15
  v_mfma_f32_32x32x16_bf16 v[160:175], v[244:247], a[108:111], v[160:175]
  v_cvt_pk_bf16_f32 v213, v60, v62
  v_cvt_pk_bf16_f32 v221, v61, v63
  s_waitcnt lgkmcnt(1)
  v_mul_f32 v56, v92, v18
  v_mul_f32 v58, v93, v19
  v_mul_f32 v57, v92, v16
  v_mul_f32 v59, v93, v17
  v_fma_f32 v56, v76, v16, -v56
  v_fma_f32 v58, v77, v17, -v58
  v_fmac_f32 v57, v76, v18
  v_fmac_f32 v59, v77, v19
  v_cvt_pk_bf16_f32 v198, v56, v58
  v_mfma_f32_32x32x16_bf16 v[176:191], v[252:255], a[108:111], v[176:191]
  v_cvt_pk_bf16_f32 v206, v57, v59
  v_mul_f32 v60, v124, v18
  v_mul_f32 v62, v125, v19
  v_mul_f32 v61, v124, v16
  v_mul_f32 v63, v125, v17
  v_fma_f32 v60, v108, v16, -v60
  v_fma_f32 v62, v109, v17, -v62
  v_fmac_f32 v61, v108, v18
  v_fmac_f32 v63, v109, v19
  v_cvt_pk_bf16_f32 v214, v60, v62
  v_mfma_f32_32x32x16_bf16 v[160:175], v[252:255], a[116:119], v[160:175]
  v_cvt_pk_bf16_f32 v222, v61, v63
  s_waitcnt lgkmcnt(0)
  v_mul_f32 v56, v94, v22
  v_mul_f32 v58, v95, v23
  v_mul_f32 v57, v94, v20
  v_mul_f32 v59, v95, v21
  v_fma_f32 v56, v78, v20, -v56
  v_fma_f32 v58, v79, v21, -v58
  v_fmac_f32 v57, v78, v22
  v_fmac_f32 v59, v79, v23
  v_cvt_pk_bf16_f32 v199, v56, v58
  v_cvt_pk_bf16_f32 v207, v57, v59
  v_mfma_f32_32x32x16_bf16 v[176:191], v[244:247], a[112:115], v[176:191]
  v_mul_f32 v60, v126, v22
  v_mul_f32 v62, v127, v23
  v_mul_f32 v61, v126, v20
  v_mul_f32 v63, v127, v21
  v_fma_f32 v60, v110, v20, -v60
  v_fma_f32 v62, v111, v21, -v62
  v_fmac_f32 v61, v110, v22
  v_fmac_f32 v63, v111, v23
  v_cvt_pk_bf16_f32 v215, v60, v62
  v_cvt_pk_bf16_f32 v223, v61, v63
  v_mfma_f32_32x32x16_bf16 v[64:79], v[192:195], a[0:3], 0
  ds_read_b128 v[8:11], v2 offset:24576
  ds_read_b128 v[12:15], v2 offset:25600
  ds_read_b128 v[16:19], v2 offset:26624
  ds_read_b128 v[20:23], v2 offset:27648
  s_waitcnt lgkmcnt(3)
  v_mul_f32 v56, v144, v10
  v_mul_f32 v58, v145, v11
  v_mul_f32 v57, v144, v8
  v_mul_f32 v59, v145, v9
  v_fma_f32 v56, v128, v8, -v56
  v_fma_f32 v58, v129, v9, -v58
  v_fmac_f32 v57, v128, v10
  v_mfma_f32_32x32x16_bf16 v[80:95], v[200:203], a[0:3], 0
  v_fmac_f32 v59, v129, v11
  v_cvt_pk_bf16_f32 v224, v56, v58
  v_cvt_pk_bf16_f32 v232, v57, v59
  v_mul_f32 v60, v176, v10
  v_mul_f32 v62, v177, v11
  v_mul_f32 v61, v176, v8
  v_mul_f32 v63, v177, v9
  v_fma_f32 v60, v160, v8, -v60
  v_fma_f32 v62, v161, v9, -v62
  v_fmac_f32 v61, v160, v10
  v_mfma_f32_32x32x16_bf16 v[64:79], v[200:203], a[64:67], v[64:79]
  v_fmac_f32 v63, v161, v11
  v_cvt_pk_bf16_f32 v240, v60, v62
  v_cvt_pk_bf16_f32 v248, v61, v63
  ds_read_b128 v[8:11], v2 offset:28672
  s_waitcnt lgkmcnt(3)
  v_mul_f32 v56, v146, v14
  v_mul_f32 v58, v147, v15
  v_mul_f32 v57, v146, v12
  v_mul_f32 v59, v147, v13
  v_fma_f32 v56, v130, v12, -v56
  v_fma_f32 v58, v131, v13, -v58
  v_fmac_f32 v57, v130, v14
  v_mfma_f32_32x32x16_bf16 v[80:95], v[192:195], a[32:35], v[80:95]
  v_fmac_f32 v59, v131, v15
  v_cvt_pk_bf16_f32 v225, v56, v58
  v_cvt_pk_bf16_f32 v233, v57, v59
  v_mul_f32 v60, v178, v14
  v_mul_f32 v62, v179, v15
  v_mul_f32 v61, v178, v12
  v_mul_f32 v63, v179, v13
  v_fma_f32 v60, v162, v12, -v60
  v_fma_f32 v62, v163, v13, -v62
  v_fmac_f32 v61, v162, v14
  v_mfma_f32_32x32x16_bf16 v[64:79], v[196:199], a[8:11], v[64:79]
  v_fmac_f32 v63, v163, v15
  v_cvt_pk_bf16_f32 v241, v60, v62
  v_cvt_pk_bf16_f32 v249, v61, v63
  ds_read_b128 v[12:15], v2 offset:29696
  s_waitcnt lgkmcnt(3)
  v_mul_f32 v56, v148, v18
  v_mul_f32 v58, v149, v19
  v_mul_f32 v57, v148, v16
  v_mul_f32 v59, v149, v17
  v_fma_f32 v56, v132, v16, -v56
  v_fma_f32 v58, v133, v17, -v58
  v_fmac_f32 v57, v132, v18
  v_mfma_f32_32x32x16_bf16 v[80:95], v[204:207], a[8:11], v[80:95]
  v_fmac_f32 v59, v133, v19
  v_cvt_pk_bf16_f32 v226, v56, v58
  v_cvt_pk_bf16_f32 v234, v57, v59
  v_mul_f32 v60, v180, v18
  v_mul_f32 v62, v181, v19
  v_mul_f32 v61, v180, v16
  v_mul_f32 v63, v181, v17
  v_fma_f32 v60, v164, v16, -v60
  v_fma_f32 v62, v165, v17, -v62
  v_fmac_f32 v61, v164, v18
  v_mfma_f32_32x32x16_bf16 v[64:79], v[204:207], a[72:75], v[64:79]
  v_fmac_f32 v63, v165, v19
  v_cvt_pk_bf16_f32 v242, v60, v62
  v_cvt_pk_bf16_f32 v250, v61, v63
  ds_read_b128 v[16:19], v2 offset:30720
  s_waitcnt lgkmcnt(3)
  v_mul_f32 v56, v150, v22
  v_mul_f32 v58, v151, v23
  v_mul_f32 v57, v150, v20
  v_mul_f32 v59, v151, v21
  v_fma_f32 v56, v134, v20, -v56
  v_fma_f32 v58, v135, v21, -v58
  v_fmac_f32 v57, v134, v22
  v_mfma_f32_32x32x16_bf16 v[80:95], v[196:199], a[40:43], v[80:95]
  v_fmac_f32 v59, v135, v23
  v_cvt_pk_bf16_f32 v227, v56, v58
  v_cvt_pk_bf16_f32 v235, v57, v59
  v_mul_f32 v60, v182, v22
  v_mul_f32 v62, v183, v23
  v_mul_f32 v61, v182, v20
  v_mul_f32 v63, v183, v21
  v_fma_f32 v60, v166, v20, -v60
  v_fma_f32 v62, v167, v21, -v62
  v_fmac_f32 v61, v166, v22
  v_mfma_f32_32x32x16_bf16 v[96:111], v[208:211], a[0:3], 0
  v_fmac_f32 v63, v167, v23
  v_cvt_pk_bf16_f32 v243, v60, v62
  v_cvt_pk_bf16_f32 v251, v61, v63
  ds_read_b128 v[20:23], v2 offset:31744
  s_waitcnt lgkmcnt(3)
  v_mul_f32 v56, v152, v10
  v_mul_f32 v58, v153, v11
  v_mul_f32 v57, v152, v8
  v_mul_f32 v59, v153, v9
  v_fma_f32 v56, v136, v8, -v56
  v_fma_f32 v58, v137, v9, -v58
  v_fmac_f32 v57, v136, v10
  v_mfma_f32_32x32x16_bf16 v[112:127], v[216:219], a[0:3], 0
  v_fmac_f32 v59, v137, v11
  v_cvt_pk_bf16_f32 v228, v56, v58
  v_cvt_pk_bf16_f32 v236, v57, v59
  v_mul_f32 v60, v184, v10
  v_mul_f32 v62, v185, v11
  v_mul_f32 v61, v184, v8
  v_mul_f32 v63, v185, v9
  v_fma_f32 v60, v168, v8, -v60
  v_fma_f32 v62, v169, v9, -v62
  v_fmac_f32 v61, v168, v10
  v_mfma_f32_32x32x16_bf16 v[96:111], v[216:219], a[64:67], v[96:111]
  v_fmac_f32 v63, v169, v11
  v_cvt_pk_bf16_f32 v244, v60, v62
  v_cvt_pk_bf16_f32 v252, v61, v63
  s_waitcnt lgkmcnt(2)
  v_mul_f32 v56, v154, v14
  v_mul_f32 v58, v155, v15
  v_mul_f32 v57, v154, v12
  v_mul_f32 v59, v155, v13
  v_fma_f32 v56, v138, v12, -v56
  v_fma_f32 v58, v139, v13, -v58
  v_fmac_f32 v57, v138, v14
  v_fmac_f32 v59, v139, v15
  v_mfma_f32_32x32x16_bf16 v[112:127], v[208:211], a[32:35], v[112:127]
  v_cvt_pk_bf16_f32 v229, v56, v58
  v_cvt_pk_bf16_f32 v237, v57, v59
  v_mul_f32 v60, v186, v14
  v_mul_f32 v62, v187, v15
  v_mul_f32 v61, v186, v12
  v_mul_f32 v63, v187, v13
  v_fma_f32 v60, v170, v12, -v60
  v_fma_f32 v62, v171, v13, -v62
  v_fmac_f32 v61, v170, v14
  v_fmac_f32 v63, v171, v15
  v_mfma_f32_32x32x16_bf16 v[96:111], v[212:215], a[8:11], v[96:111]
  v_cvt_pk_bf16_f32 v245, v60, v62
  v_cvt_pk_bf16_f32 v253, v61, v63
  s_waitcnt lgkmcnt(1)
  v_mul_f32 v56, v156, v18
  v_mul_f32 v58, v157, v19
  v_mul_f32 v57, v156, v16
  v_mul_f32 v59, v157, v17
  v_fma_f32 v56, v140, v16, -v56
  v_fma_f32 v58, v141, v17, -v58
  v_fmac_f32 v57, v140, v18
  v_fmac_f32 v59, v141, v19
  v_cvt_pk_bf16_f32 v230, v56, v58
  v_mfma_f32_32x32x16_bf16 v[112:127], v[220:223], a[8:11], v[112:127]
  v_cvt_pk_bf16_f32 v238, v57, v59
  v_mul_f32 v60, v188, v18
  v_mul_f32 v62, v189, v19
  v_mul_f32 v61, v188, v16
  v_mul_f32 v63, v189, v17
  v_fma_f32 v60, v172, v16, -v60
  v_fma_f32 v62, v173, v17, -v62
  v_fmac_f32 v61, v172, v18
  v_fmac_f32 v63, v173, v19
  v_cvt_pk_bf16_f32 v246, v60, v62
  v_mfma_f32_32x32x16_bf16 v[96:111], v[220:223], a[72:75], v[96:111]
  v_cvt_pk_bf16_f32 v254, v61, v63
  s_waitcnt lgkmcnt(0)
  v_mul_f32 v56, v158, v22
  v_mul_f32 v58, v159, v23
  v_mul_f32 v57, v158, v20
  v_mul_f32 v59, v159, v21
  v_fma_f32 v56, v142, v20, -v56
  v_fma_f32 v58, v143, v21, -v58
  v_fmac_f32 v57, v142, v22
  v_fmac_f32 v59, v143, v23
  v_cvt_pk_bf16_f32 v231, v56, v58
  v_cvt_pk_bf16_f32 v239, v57, v59
  v_mfma_f32_32x32x16_bf16 v[112:127], v[212:215], a[40:43], v[112:127]
  v_mul_f32 v60, v190, v22
  v_mul_f32 v62, v191, v23
  v_mul_f32 v61, v190, v20
  v_mul_f32 v63, v191, v21
  v_fma_f32 v60, v174, v20, -v60
  v_fma_f32 v62, v175, v21, -v62
  v_fmac_f32 v61, v174, v22
  v_fmac_f32 v63, v175, v23
  v_cvt_pk_bf16_f32 v247, v60, v62
  v_cvt_pk_bf16_f32 v255, v61, v63
  s_and_b32 s68, s65, 7
  s_lshl_b32 s69, s64, 2
  s_lshr_b32 s44, s65, 3
  s_add_u32 s69, s69, s44
  v_lshrrev_b32 v24, 3, v1
  v_and_b32 v25, 7, v1
  v_bfe_u32 v26, v1, 4, 1
  v_lshlrev_b32 v26, 2, v26
  v_xor_b32 v25, v25, v26
  v_lshlrev_b32 v25, 4, v25
  v_lshlrev_b32 v24, 12, v24
  v_add_u32 v28, v24, v25
  v_add_u32 v29, 31744, v28
  v_lshrrev_b32 v24, 5, v1
  v_lshlrev_b32 v24, 9, v24
  v_bfe_u32 v25, v1, 2, 2
  v_lshlrev_b32 v25, 7, v25
  v_add_u32 v24, v24, v25
  v_bfe_u32 v25, v1, 4, 1
  v_lshlrev_b32 v25, 5, v25
  v_add_u32 v24, v24, v25
  v_and_b32 v25, 3, v1
  v_lshlrev_b32 v25, 3, v25
  v_add_u32 v24, v24, v25
  v_bfe_u32 v25, v1, 3, 1
  v_lshlrev_b32 v25, 6, v25
  v_xor_b32 v30, v24, v25
  s_and_b32 s45, s3, 1
  s_lshl_b32 s44, s45, 6
  v_xor_b32 v30, s44, v30
  s_mul_i32 s98, s3, 28672
  s_add_u32 s98, s98, 49152
  v_add_u32 v30, s98, v30
  v_xor_b32 v31, 64, v30
  s_mul_i32 s99, s3, 1835008
  s_lshl_b32 s44, s69, 7
  s_add_u32 s99, s99, s44
  s_mov_b32 s24, s16
  s_and_b32 s25, s17, 0xffff
  s_mov_b32 s26, 7340032
  s_mov_b32 s27, 0x20000
  v_mfma_f32_32x32x16_bf16 v[64:79], v[224:227], a[16:19], v[64:79]
  v_mfma_f32_32x32x16_bf16 v[80:95], v[232:235], a[16:19], v[80:95]
  v_mfma_f32_32x32x16_bf16 v[64:79], v[232:235], a[80:83], v[64:79]
  v_mfma_f32_32x32x16_bf16 v[80:95], v[224:227], a[48:51], v[80:95]
  v_mfma_f32_32x32x16_bf16 v[64:79], v[228:231], a[24:27], v[64:79]
  v_mfma_f32_32x32x16_bf16 v[80:95], v[236:239], a[24:27], v[80:95]
  v_mfma_f32_32x32x16_bf16 v[64:79], v[236:239], a[88:91], v[64:79]
  v_mfma_f32_32x32x16_bf16 v[80:95], v[228:231], a[56:59], v[80:95]
  v_mfma_f32_32x32x16_bf16 v[96:111], v[240:243], a[16:19], v[96:111]
  v_mfma_f32_32x32x16_bf16 v[112:127], v[248:251], a[16:19], v[112:127]
  v_mfma_f32_32x32x16_bf16 v[96:111], v[248:251], a[80:83], v[96:111]
  v_mfma_f32_32x32x16_bf16 v[112:127], v[240:243], a[48:51], v[112:127]
  v_mfma_f32_32x32x16_bf16 v[96:111], v[244:247], a[24:27], v[96:111]
  v_mfma_f32_32x32x16_bf16 v[112:127], v[252:255], a[24:27], v[112:127]
  v_mfma_f32_32x32x16_bf16 v[96:111], v[252:255], a[88:91], v[96:111]
  v_mfma_f32_32x32x16_bf16 v[112:127], v[244:247], a[56:59], v[112:127]
  v_mfma_f32_32x32x16_bf16 v[128:143], v[192:195], a[4:7], 0
  v_mfma_f32_32x32x16_bf16 v[144:159], v[200:203], a[4:7], 0
  v_mfma_f32_32x32x16_bf16 v[128:143], v[200:203], a[68:71], v[128:143]
  v_cvt_pk_bf16_f32 v8, v64, v65
  v_cvt_pk_bf16_f32 v9, v66, v67
  v_cvt_pk_bf16_f32 v10, v68, v69
  v_cvt_pk_bf16_f32 v11, v70, v71
  v_mfma_f32_32x32x16_bf16 v[144:159], v[192:195], a[36:39], v[144:159]
  v_cvt_pk_bf16_f32 v12, v72, v73
  v_cvt_pk_bf16_f32 v13, v74, v75
  v_cvt_pk_bf16_f32 v14, v76, v77
  v_cvt_pk_bf16_f32 v15, v78, v79
  v_mfma_f32_32x32x16_bf16 v[128:143], v[196:199], a[12:15], v[128:143]
  ds_write_b128 v5, v[8:11] offset:0
  ds_write_b128 v5, v[12:15] offset:16
  v_cvt_pk_bf16_f32 v16, v80, v81
  v_cvt_pk_bf16_f32 v17, v82, v83
  v_mfma_f32_32x32x16_bf16 v[144:159], v[204:207], a[12:15], v[144:159]
  v_cvt_pk_bf16_f32 v18, v84, v85
  v_cvt_pk_bf16_f32 v19, v86, v87
  v_cvt_pk_bf16_f32 v20, v88, v89
  v_cvt_pk_bf16_f32 v21, v90, v91
  v_mfma_f32_32x32x16_bf16 v[128:143], v[204:207], a[76:79], v[128:143]
  v_cvt_pk_bf16_f32 v22, v92, v93
  v_cvt_pk_bf16_f32 v23, v94, v95
  ds_write_b128 v5, v[16:19] offset:2048
  ds_write_b128 v5, v[20:23] offset:2064
  v_mfma_f32_32x32x16_bf16 v[144:159], v[196:199], a[44:47], v[144:159]
  s_waitcnt lgkmcnt(2)
  ds_read_b128 v[64:67], v6 offset:0
  ds_read_b128 v[68:71], v6 offset:1024
  s_waitcnt lgkmcnt(2)
  ds_read_b128 v[80:83], v6 offset:2048
  ds_read_b128 v[84:87], v6 offset:3072
  v_mfma_f32_32x32x16_bf16 v[128:143], v[224:227], a[20:23], v[128:143]
  s_waitcnt lgkmcnt(3)
  buffer_store_dwordx4 v[64:67], v2, s[28:31], s48 offen offset:0 sc1
  s_waitcnt lgkmcnt(2)
  buffer_store_dwordx4 v[68:71], v2, s[28:31], s48 offen offset:1024 sc1
  s_waitcnt lgkmcnt(1)
  buffer_store_dwordx4 v[80:83], v2, s[28:31], s49 offen offset:0 sc1
  s_waitcnt lgkmcnt(0)
  buffer_store_dwordx4 v[84:87], v2, s[28:31], s49 offen offset:1024 sc1
  v_mfma_f32_32x32x16_bf16 v[144:159], v[232:235], a[20:23], v[144:159]
  v_cvt_pk_bf16_f32 v8, v96, v97
  v_cvt_pk_bf16_f32 v9, v98, v99
  v_cvt_pk_bf16_f32 v10, v100, v101
  v_cvt_pk_bf16_f32 v11, v102, v103
  v_mfma_f32_32x32x16_bf16 v[128:143], v[232:235], a[84:87], v[128:143]
  v_cvt_pk_bf16_f32 v12, v104, v105
  v_cvt_pk_bf16_f32 v13, v106, v107
  v_cvt_pk_bf16_f32 v14, v108, v109
  v_cvt_pk_bf16_f32 v15, v110, v111
  v_mfma_f32_32x32x16_bf16 v[144:159], v[224:227], a[52:55], v[144:159]
  ds_write_b128 v5, v[8:11] offset:0
  ds_write_b128 v5, v[12:15] offset:16
  v_cvt_pk_bf16_f32 v16, v112, v113
  v_cvt_pk_bf16_f32 v17, v114, v115
  v_mfma_f32_32x32x16_bf16 v[128:143], v[228:231], a[28:31], v[128:143]
  v_cvt_pk_bf16_f32 v18, v116, v117
  v_cvt_pk_bf16_f32 v19, v118, v119
  v_cvt_pk_bf16_f32 v20, v120, v121
  v_cvt_pk_bf16_f32 v21, v122, v123
  v_mfma_f32_32x32x16_bf16 v[144:159], v[236:239], a[28:31], v[144:159]
  v_cvt_pk_bf16_f32 v22, v124, v125
  v_cvt_pk_bf16_f32 v23, v126, v127
  ds_write_b128 v5, v[16:19] offset:2048
  ds_write_b128 v5, v[20:23] offset:2064
  v_mfma_f32_32x32x16_bf16 v[128:143], v[236:239], a[92:95], v[128:143]
  s_waitcnt lgkmcnt(2)
  ds_read_b128 v[96:99], v6 offset:0
  ds_read_b128 v[100:103], v6 offset:1024
  s_waitcnt lgkmcnt(2)
  ds_read_b128 v[112:115], v6 offset:2048
  ds_read_b128 v[116:119], v6 offset:3072
  v_mfma_f32_32x32x16_bf16 v[144:159], v[228:231], a[60:63], v[144:159]
  s_waitcnt lgkmcnt(3)
  buffer_store_dwordx4 v[96:99], v2, s[28:31], s50 offen offset:0 sc1
  s_waitcnt lgkmcnt(2)
  buffer_store_dwordx4 v[100:103], v2, s[28:31], s50 offen offset:1024 sc1
  s_waitcnt lgkmcnt(1)
  buffer_store_dwordx4 v[112:115], v2, s[28:31], s51 offen offset:0 sc1
  s_waitcnt lgkmcnt(0)
  buffer_store_dwordx4 v[116:119], v2, s[28:31], s51 offen offset:1024 sc1
  v_mfma_f32_32x32x16_bf16 v[160:175], v[208:211], a[4:7], 0
  v_mfma_f32_32x32x16_bf16 v[176:191], v[216:219], a[4:7], 0
  v_mfma_f32_32x32x16_bf16 v[160:175], v[216:219], a[68:71], v[160:175]
  v_cvt_pk_bf16_f32 v8, v128, v129
  v_cvt_pk_bf16_f32 v9, v130, v131
  v_mfma_f32_32x32x16_bf16 v[176:191], v[208:211], a[36:39], v[176:191]
  v_cvt_pk_bf16_f32 v10, v132, v133
  v_cvt_pk_bf16_f32 v11, v134, v135
  v_mfma_f32_32x32x16_bf16 v[160:175], v[212:215], a[12:15], v[160:175]
  v_cvt_pk_bf16_f32 v12, v136, v137
  v_cvt_pk_bf16_f32 v13, v138, v139
  v_mfma_f32_32x32x16_bf16 v[176:191], v[220:223], a[12:15], v[176:191]
  v_cvt_pk_bf16_f32 v14, v140, v141
  v_cvt_pk_bf16_f32 v15, v142, v143
  v_mfma_f32_32x32x16_bf16 v[160:175], v[220:223], a[76:79], v[160:175]
  ds_write_b128 v5, v[8:11] offset:0
  ds_write_b128 v5, v[12:15] offset:16
  v_mfma_f32_32x32x16_bf16 v[176:191], v[212:215], a[44:47], v[176:191]
  v_cvt_pk_bf16_f32 v16, v144, v145
  v_cvt_pk_bf16_f32 v17, v146, v147
  v_mfma_f32_32x32x16_bf16 v[160:175], v[240:243], a[20:23], v[160:175]
  v_cvt_pk_bf16_f32 v18, v148, v149
  v_cvt_pk_bf16_f32 v19, v150, v151
  v_mfma_f32_32x32x16_bf16 v[176:191], v[248:251], a[20:23], v[176:191]
  v_cvt_pk_bf16_f32 v20, v152, v153
  v_cvt_pk_bf16_f32 v21, v154, v155
  v_mfma_f32_32x32x16_bf16 v[160:175], v[248:251], a[84:87], v[160:175]
  v_cvt_pk_bf16_f32 v22, v156, v157
  v_cvt_pk_bf16_f32 v23, v158, v159
  v_mfma_f32_32x32x16_bf16 v[176:191], v[240:243], a[52:55], v[176:191]
  ds_write_b128 v5, v[16:19] offset:2048
  ds_write_b128 v5, v[20:23] offset:2064
  v_mfma_f32_32x32x16_bf16 v[160:175], v[244:247], a[28:31], v[160:175]
  s_waitcnt lgkmcnt(2)
  ds_read_b128 v[128:131], v6 offset:0
  ds_read_b128 v[132:135], v6 offset:1024
  v_mfma_f32_32x32x16_bf16 v[176:191], v[252:255], a[28:31], v[176:191]
  s_waitcnt lgkmcnt(2)
  ds_read_b128 v[144:147], v6 offset:2048
  ds_read_b128 v[148:151], v6 offset:3072
  v_mfma_f32_32x32x16_bf16 v[160:175], v[252:255], a[92:95], v[160:175]
  s_waitcnt lgkmcnt(3)
  buffer_store_dwordx4 v[128:131], v2, s[28:31], s48 offen offset:2048 sc1
  s_waitcnt lgkmcnt(2)
  buffer_store_dwordx4 v[132:135], v2, s[28:31], s48 offen offset:3072 sc1
  v_mfma_f32_32x32x16_bf16 v[176:191], v[244:247], a[60:63], v[176:191]
  s_waitcnt lgkmcnt(1)
  buffer_store_dwordx4 v[144:147], v2, s[28:31], s49 offen offset:2048 sc1
  s_waitcnt lgkmcnt(0)
  buffer_store_dwordx4 v[148:151], v2, s[28:31], s49 offen offset:3072 sc1
  s_nop 2
  v_cvt_pk_bf16_f32 v8, v160, v161
  v_cvt_pk_bf16_f32 v9, v162, v163
  v_cvt_pk_bf16_f32 v10, v164, v165
  v_cvt_pk_bf16_f32 v11, v166, v167
  v_cvt_pk_bf16_f32 v12, v168, v169
  v_cvt_pk_bf16_f32 v13, v170, v171
  v_cvt_pk_bf16_f32 v14, v172, v173
  v_cvt_pk_bf16_f32 v15, v174, v175
  ds_write_b128 v5, v[8:11] offset:0
  ds_write_b128 v5, v[12:15] offset:16
  v_cvt_pk_bf16_f32 v16, v176, v177
  v_cvt_pk_bf16_f32 v17, v178, v179
  v_cvt_pk_bf16_f32 v18, v180, v181
  v_cvt_pk_bf16_f32 v19, v182, v183
  v_cvt_pk_bf16_f32 v20, v184, v185
  v_cvt_pk_bf16_f32 v21, v186, v187
  v_cvt_pk_bf16_f32 v22, v188, v189
  v_cvt_pk_bf16_f32 v23, v190, v191
  ds_write_b128 v5, v[16:19] offset:2048
  ds_write_b128 v5, v[20:23] offset:2064
  s_waitcnt lgkmcnt(2)
  ds_read_b128 v[160:163], v6 offset:0
  ds_read_b128 v[164:167], v6 offset:1024
  s_waitcnt lgkmcnt(2)
  ds_read_b128 v[176:179], v6 offset:2048
  ds_read_b128 v[180:183], v6 offset:3072
  s_waitcnt lgkmcnt(3)
  buffer_store_dwordx4 v[160:163], v2, s[28:31], s50 offen offset:2048 sc1
  s_waitcnt lgkmcnt(2)
  buffer_store_dwordx4 v[164:167], v2, s[28:31], s50 offen offset:3072 sc1
  s_waitcnt lgkmcnt(1)
  buffer_store_dwordx4 v[176:179], v2, s[28:31], s51 offen offset:2048 sc1
  s_waitcnt lgkmcnt(0)
  buffer_store_dwordx4 v[180:183], v2, s[28:31], s51 offen offset:3072 sc1
  s_lshl_b32 s72, s64, 7
  s_add_u32 s72, s72, 12591104
  s_mov_b32 s100, s72
  s_and_b32 s45, s3, 1
  s_lshr_b32 s46, s3, 1
  s_lshl_b32 s44, s69, 7
  s_lshl_b32 s51, s3, 19
  s_add_u32 s51, s51, s44
  s_add_u32 s51, s51, 7340032
  v_lshlrev_b32 v8, 4, v1
  s_lshl_b32 s44, s46, 10
  v_add_u32 v48, s44, v8
  s_xor_b32 s44, s44, 1024
  v_add_u32 v49, s44, v8
  s_mul_i32 s44, s68, 144
  s_lshl_b32 s97, s3, 3
  s_add_u32 s97, s97, s44
  s_add_u32 s97, s97, 112
  s_lshl_b32 s97, s97, 11
  s_add_u32 s97, s97, 2097152
  s_mul_i32 s55, s3, 28
  s_add_u32 s55, s55, s44
  s_lshl_b32 s55, s55, 11
  s_add_u32 s55, s55, 2097152
  v_and_b32 v61, 31, v1
  v_lshlrev_b32 v9, 10, v61
  v_lshrrev_b32 v10, 5, v1
  v_lshlrev_b32 v10, 5, v10
  v_add_u32 v60, v9, v10
  s_lshl_b32 s58, s69, 1
  s_add_u32 s58, s58, s45
  s_lshl_b32 s59, s58, 15
  s_lshl_b32 s44, s68, 1
  s_add_u32 s44, s44, s46
  s_lshl_b32 s44, s44, 6
  s_add_u32 s59, s59, s44
  s_lshl_b32 s58, s58, 6
  v_lshlrev_b32 v61, 1, v61
  s_mov_b32 s40, s4
  s_and_b32 s41, s5, 0xffff
  s_mov_b32 s42, 2097152
  s_mov_b32 s43, 0x20000
  s_add_u32 m0, s98, 0
  s_nop 0
  buffer_load_dwordx4 v28, s[24:27], s99 offen  lds
  buffer_load_dwordx4 v29, s[24:27], s99 offen offset:1024  lds
  s_add_u32 s99, s99, 65536
  s_add_u32 m0, s98, 2048
  s_nop 0
  buffer_load_dwordx4 v28, s[24:27], s99 offen  lds
  buffer_load_dwordx4 v29, s[24:27], s99 offen offset:1024  lds
  s_add_u32 s99, s99, 65536
  s_add_u32 m0, s98, 4096
  s_nop 0
  buffer_load_dwordx4 v28, s[24:27], s99 offen  lds
  buffer_load_dwordx4 v29, s[24:27], s99 offen offset:1024  lds
  s_add_u32 s99, s99, 65536
  s_add_u32 m0, s98, 6144
  s_nop 0
  buffer_load_dwordx4 v28, s[24:27], s99 offen  lds
  buffer_load_dwordx4 v29, s[24:27], s99 offen offset:1024  lds
  s_add_u32 s99, s99, 65536
  s_add_u32 m0, s98, 8192
  s_nop 0
  buffer_load_dwordx4 v28, s[24:27], s99 offen  lds
  buffer_load_dwordx4 v29, s[24:27], s99 offen offset:1024  lds
  s_add_u32 s99, s99, 65536
  s_add_u32 m0, s98, 10240
  s_nop 0
  buffer_load_dwordx4 v28, s[24:27], s99 offen  lds
  buffer_load_dwordx4 v29, s[24:27], s99 offen offset:1024  lds
  s_add_u32 s99, s99, 65536
  s_add_u32 m0, s98, 12288
  s_nop 0
  buffer_load_dwordx4 v28, s[24:27], s99 offen  lds
  buffer_load_dwordx4 v29, s[24:27], s99 offen offset:1024  lds
  s_add_u32 s99, s99, 65536
  s_add_u32 m0, s98, 14336
  s_nop 0
  buffer_load_dwordx4 v28, s[24:27], s99 offen  lds
  buffer_load_dwordx4 v29, s[24:27], s99 offen offset:1024  lds
  s_add_u32 s99, s99, 65536
  s_add_u32 m0, s98, 16384
  s_nop 0
  buffer_load_dwordx4 v28, s[24:27], s99 offen  lds
  buffer_load_dwordx4 v29, s[24:27], s99 offen offset:1024  lds
  s_add_u32 s99, s99, 65536
  s_add_u32 m0, s98, 18432
  s_nop 0
  buffer_load_dwordx4 v28, s[24:27], s99 offen  lds
  buffer_load_dwordx4 v29, s[24:27], s99 offen offset:1024  lds
  s_add_u32 s99, s99, 65536
  s_add_u32 m0, s98, 20480
  s_nop 0
  buffer_load_dwordx4 v28, s[24:27], s99 offen  lds
  buffer_load_dwordx4 v29, s[24:27], s99 offen offset:1024  lds
  s_add_u32 s99, s99, 65536
  s_add_u32 m0, s98, 22528
  s_nop 0
  buffer_load_dwordx4 v28, s[24:27], s99 offen  lds
  buffer_load_dwordx4 v29, s[24:27], s99 offen offset:1024  lds
  s_add_u32 s99, s99, 65536
  s_add_u32 m0, s98, 24576
  s_nop 0
  buffer_load_dwordx4 v28, s[24:27], s99 offen  lds
  buffer_load_dwordx4 v29, s[24:27], s99 offen offset:1024  lds
  s_add_u32 s99, s99, 65536
  s_add_u32 m0, s98, 26624
  s_nop 0
  buffer_load_dwordx4 v28, s[24:27], s99 offen  lds
  buffer_load_dwordx4 v29, s[24:27], s99 offen offset:1024  lds
  s_add_u32 s99, s99, 65536
  s_waitcnt vmcnt(0)
  s_barrier
  s_cmp_lg_u32 s3, 0
  s_cbranch_scc1 fz_sz_skip
  v_mov_b32 v44, 0
  v_mov_b32 v45, 1
  s_mov_b64 exec, 1
  buffer_atomic_add v45, v44, s[28:31], s100 offen sc1
  s_mov_b64 exec, -1
fz_sz_skip:
  s_lshl_b32 s74, s68, 9
  s_add_u32 s74, s74, 12587008
  v_lshlrev_b32 v32, 7, v1
  v_mov_b32 v33, 7
  s_mov_b32 exec_lo, 0xf
  s_mov_b32 exec_hi, 0
  buffer_load_dword v34, v32, s[28:31], s74 offen sc1
  s_mov_b64 exec, -1
  ds_read_b64_tr_b16 a[0:1], v30 offset:0
  ds_read_b64_tr_b16 a[2:3], v30 offset:1024
  ds_read_b64_tr_b16 a[4:5], v31 offset:0
  ds_read_b64_tr_b16 a[6:7], v31 offset:1024
  ds_read_b64_tr_b16 a[8:9], v30 offset:2048
  ds_read_b64_tr_b16 a[10:11], v30 offset:3072
  ds_read_b64_tr_b16 a[12:13], v31 offset:2048
  ds_read_b64_tr_b16 a[14:15], v31 offset:3072
  s_waitcnt lgkmcnt(4)
  s_add_u32 m0, s98, 0
  s_nop 0
  buffer_load_dwordx4 v28, s[24:27], s99 offen  lds
  buffer_load_dwordx4 v29, s[24:27], s99 offen offset:1024  lds
  s_add_u32 s99, s99, 65536
  ds_read_b64_tr_b16 a[16:17], v30 offset:4096
  ds_read_b64_tr_b16 a[18:19], v30 offset:5120
  ds_read_b64_tr_b16 a[20:21], v31 offset:4096
  ds_read_b64_tr_b16 a[22:23], v31 offset:5120
  s_waitcnt lgkmcnt(4)
  s_add_u32 m0, s98, 2048
  s_nop 0
  buffer_load_dwordx4 v28, s[24:27], s99 offen  lds
  buffer_load_dwordx4 v29, s[24:27], s99 offen offset:1024  lds
  s_add_u32 s99, s99, 65536
  ds_read_b64_tr_b16 a[24:25], v30 offset:6144
  ds_read_b64_tr_b16 a[26:27], v30 offset:7168
  ds_read_b64_tr_b16 a[28:29], v31 offset:6144
  ds_read_b64_tr_b16 a[30:31], v31 offset:7168
  s_waitcnt lgkmcnt(4)
  s_add_u32 m0, s98, 4096
  s_nop 0
  buffer_load_dwordx4 v28, s[24:27], s99 offen  lds
  buffer_load_dwordx4 v29, s[24:27], s99 offen offset:1024  lds
  s_add_u32 s99, s99, 65536
  ds_read_b64_tr_b16 a[32:33], v30 offset:8192
  ds_read_b64_tr_b16 a[34:35], v30 offset:9216
  ds_read_b64_tr_b16 a[36:37], v31 offset:8192
  ds_read_b64_tr_b16 a[38:39], v31 offset:9216
  s_waitcnt lgkmcnt(4)
  s_add_u32 m0, s98, 6144
  s_nop 0
  buffer_load_dwordx4 v28, s[24:27], s99 offen  lds
  buffer_load_dwordx4 v29, s[24:27], s99 offen offset:1024  lds
  s_add_u32 s99, s99, 65536
  ds_read_b64_tr_b16 a[40:41], v30 offset:10240
  ds_read_b64_tr_b16 a[42:43], v30 offset:11264
  ds_read_b64_tr_b16 a[44:45], v31 offset:10240
  ds_read_b64_tr_b16 a[46:47], v31 offset:11264
  s_waitcnt lgkmcnt(4)
  s_add_u32 m0, s98, 8192
  s_nop 0
  buffer_load_dwordx4 v28, s[24:27], s99 offen  lds
  buffer_load_dwordx4 v29, s[24:27], s99 offen offset:1024  lds
  s_add_u32 s99, s99, 65536
  ds_read_b64_tr_b16 a[48:49], v30 offset:12288
  ds_read_b64_tr_b16 a[50:51], v30 offset:13312
  ds_read_b64_tr_b16 a[52:53], v31 offset:12288
  ds_read_b64_tr_b16 a[54:55], v31 offset:13312
  s_waitcnt lgkmcnt(4)
  s_add_u32 m0, s98, 10240
  s_nop 0
  buffer_load_dwordx4 v28, s[24:27], s99 offen  lds
  buffer_load_dwordx4 v29, s[24:27], s99 offen offset:1024  lds
  s_add_u32 s99, s99, 65536
  ds_read_b64_tr_b16 a[56:57], v30 offset:14336
  ds_read_b64_tr_b16 a[58:59], v30 offset:15360
  ds_read_b64_tr_b16 a[60:61], v31 offset:14336
  ds_read_b64_tr_b16 a[62:63], v31 offset:15360
  s_waitcnt lgkmcnt(4)
  s_add_u32 m0, s98, 12288
  s_nop 0
  buffer_load_dwordx4 v28, s[24:27], s99 offen  lds
  buffer_load_dwordx4 v29, s[24:27], s99 offen offset:1024  lds
  s_add_u32 s99, s99, 65536
  ds_read_b64_tr_b16 a[64:65], v30 offset:16384
  ds_read_b64_tr_b16 a[66:67], v30 offset:17408
  ds_read_b64_tr_b16 a[68:69], v31 offset:16384
  ds_read_b64_tr_b16 a[70:71], v31 offset:17408
  s_waitcnt lgkmcnt(4)
  s_add_u32 m0, s98, 14336
  s_nop 0
  buffer_load_dwordx4 v28, s[24:27], s99 offen  lds
  buffer_load_dwordx4 v29, s[24:27], s99 offen offset:1024  lds
  s_add_u32 s99, s99, 65536
  ds_read_b64_tr_b16 a[72:73], v30 offset:18432
  ds_read_b64_tr_b16 a[74:75], v30 offset:19456
  ds_read_b64_tr_b16 a[76:77], v31 offset:18432
  ds_read_b64_tr_b16 a[78:79], v31 offset:19456
  s_waitcnt lgkmcnt(4)
  s_add_u32 m0, s98, 16384
  s_nop 0
  buffer_load_dwordx4 v28, s[24:27], s99 offen  lds
  buffer_load_dwordx4 v29, s[24:27], s99 offen offset:1024  lds
  s_add_u32 s99, s99, 65536
  ds_read_b64_tr_b16 a[80:81], v30 offset:20480
  ds_read_b64_tr_b16 a[82:83], v30 offset:21504
  ds_read_b64_tr_b16 a[84:85], v31 offset:20480
  ds_read_b64_tr_b16 a[86:87], v31 offset:21504
  s_waitcnt lgkmcnt(4)
  s_add_u32 m0, s98, 18432
  s_nop 0
  buffer_load_dwordx4 v28, s[24:27], s99 offen  lds
  buffer_load_dwordx4 v29, s[24:27], s99 offen offset:1024  lds
  s_add_u32 s99, s99, 65536
  ds_read_b64_tr_b16 a[88:89], v30 offset:22528
  ds_read_b64_tr_b16 a[90:91], v30 offset:23552
  ds_read_b64_tr_b16 a[92:93], v31 offset:22528
  ds_read_b64_tr_b16 a[94:95], v31 offset:23552
  s_waitcnt lgkmcnt(4)
  s_add_u32 m0, s98, 20480
  s_nop 0
  buffer_load_dwordx4 v28, s[24:27], s99 offen  lds
  buffer_load_dwordx4 v29, s[24:27], s99 offen offset:1024  lds
  s_add_u32 s99, s99, 65536
  ds_read_b64_tr_b16 a[96:97], v30 offset:24576
  ds_read_b64_tr_b16 a[98:99], v30 offset:25600
  ds_read_b64_tr_b16 a[100:101], v31 offset:24576
  ds_read_b64_tr_b16 a[102:103], v31 offset:25600
  s_waitcnt lgkmcnt(4)
  s_add_u32 m0, s98, 22528
  s_nop 0
  buffer_load_dwordx4 v28, s[24:27], s99 offen  lds
  buffer_load_dwordx4 v29, s[24:27], s99 offen offset:1024  lds
  s_add_u32 s99, s99, 65536
  ds_read_b64_tr_b16 a[104:105], v30 offset:26624
  ds_read_b64_tr_b16 a[106:107], v30 offset:27648
  ds_read_b64_tr_b16 a[108:109], v31 offset:26624
  ds_read_b64_tr_b16 a[110:111], v31 offset:27648
  s_waitcnt lgkmcnt(4)
  s_add_u32 m0, s98, 24576
  s_nop 0
  buffer_load_dwordx4 v28, s[24:27], s99 offen  lds
  buffer_load_dwordx4 v29, s[24:27], s99 offen offset:1024  lds
  s_add_u32 s99, s99, 65536
  s_waitcnt lgkmcnt(0)
  s_add_u32 m0, s98, 26624
  s_nop 0
  buffer_load_dwordx4 v28, s[24:27], s99 offen  lds
  buffer_load_dwordx4 v29, s[24:27], s99 offen offset:1024  lds
  s_add_u32 s99, s99, 65536
  v_lshlrev_b32 v8, 4, v1
  s_xor_b32 s53, s3, 1
  s_mul_i32 s53, s53, 12288
  v_add_u32 v9, s53, v8
  s_xor_b32 s53, s3, 2
  s_mul_i32 s53, s53, 12288
  s_add_u32 s53, s53, 4096
  v_add_u32 v10, s53, v8
  s_xor_b32 s53, s3, 3
  s_mul_i32 s53, s53, 12288
  s_add_u32 s53, s53, 8192
  v_add_u32 v11, s53, v8
  s_mul_i32 s53, s3, 12288
  v_add_u32 v12, s53, v8
  s_mov_b32 s73, 0
  s_waitcnt vmcnt(28)
  v_mov_b32 v35, v34
  s_mov_b32 exec_lo, 0xf
  s_mov_b32 exec_hi, 0
fzf_gc_l:
  v_cmp_ge_u32 vcc, v35, v33
  s_nop 2
  s_cmp_eq_u64 vcc, exec
  s_cbranch_scc1 fzf_gc_d
  buffer_load_dword v35, v32, s[28:31], s74 offen sc1
  s_add_u32 s73, s73, 1
  s_waitcnt vmcnt(0)
  s_cmp_lt_u32 s73, 131072
  s_cbranch_scc1 fzf_gc_l
fzf_gc_d:
  s_mov_b64 exec, -1
  buffer_load_dwordx4 v[128:131], v48, s[28:31], s55 offen sc1
  buffer_load_dwordx4 v[132:135], v49, s[28:31], s55 offen sc1
  s_add_u32 s55, s55, 2048
  buffer_load_dwordx4 v[136:139], v48, s[28:31], s55 offen sc1
  buffer_load_dwordx4 v[140:143], v49, s[28:31], s55 offen sc1
  s_add_u32 s55, s55, 2048
  buffer_load_dwordx4 v[144:147], v48, s[28:31], s55 offen sc1
  buffer_load_dwordx4 v[148:151], v49, s[28:31], s55 offen sc1
  s_add_u32 s55, s55, 2048
  buffer_load_dwordx4 v[152:155], v48, s[28:31], s55 offen sc1
  buffer_load_dwordx4 v[156:159], v49, s[28:31], s55 offen sc1
  s_add_u32 s55, s55, 2048
  buffer_load_dwordx4 v[160:163], v48, s[28:31], s55 offen sc1
  buffer_load_dwordx4 v[164:167], v49, s[28:31], s55 offen sc1
  s_add_u32 s55, s55, 2048
  buffer_load_dwordx4 v[168:171], v48, s[28:31], s55 offen sc1
  buffer_load_dwordx4 v[172:175], v49, s[28:31], s55 offen sc1
  s_add_u32 s55, s55, 2048
  buffer_load_dwordx4 v[176:179], v48, s[28:31], s55 offen sc1
  buffer_load_dwordx4 v[180:183], v49, s[28:31], s55 offen sc1
  s_add_u32 s55, s55, 2048
  buffer_load_dwordx4 v[184:187], v48, s[28:31], s55 offen sc1
  buffer_load_dwordx4 v[188:191], v49, s[28:31], s55 offen sc1
  s_add_u32 s55, s55, 2048
  s_waitcnt vmcnt(15)
  v_mfma_f32_32x32x16_bf16 v[64:79], v[128:131], a[0:3], 0
  v_mfma_f32_32x32x16_bf16 v[80:95], v[128:131], a[4:7], 0
  buffer_load_dwordx4 v[128:131], v48, s[28:31], s55 offen sc1
  s_waitcnt vmcnt(15)
  v_mfma_f32_32x32x16_bf16 v[96:111], v[132:135], a[0:3], 0
  v_mfma_f32_32x32x16_bf16 v[112:127], v[132:135], a[4:7], 0
  buffer_load_dwordx4 v[132:135], v49, s[28:31], s55 offen sc1
  s_add_u32 s55, s55, 2048
  s_waitcnt vmcnt(15)
  v_mfma_f32_32x32x16_bf16 v[64:79], v[136:139], a[8:11], v[64:79]
  v_mfma_f32_32x32x16_bf16 v[80:95], v[136:139], a[12:15], v[80:95]
  buffer_load_dwordx4 v[136:139], v48, s[28:31], s55 offen sc1
  s_waitcnt vmcnt(15)
  v_mfma_f32_32x32x16_bf16 v[96:111], v[140:143], a[8:11], v[96:111]
  v_mfma_f32_32x32x16_bf16 v[112:127], v[140:143], a[12:15], v[112:127]
  buffer_load_dwordx4 v[140:143], v49, s[28:31], s55 offen sc1
  s_add_u32 s55, s55, 2048
  s_waitcnt vmcnt(15)
  v_mfma_f32_32x32x16_bf16 v[64:79], v[144:147], a[16:19], v[64:79]
  v_mfma_f32_32x32x16_bf16 v[80:95], v[144:147], a[20:23], v[80:95]
  buffer_load_dwordx4 v[144:147], v48, s[28:31], s55 offen sc1
  s_waitcnt vmcnt(15)
  v_mfma_f32_32x32x16_bf16 v[96:111], v[148:151], a[16:19], v[96:111]
  v_mfma_f32_32x32x16_bf16 v[112:127], v[148:151], a[20:23], v[112:127]
  buffer_load_dwordx4 v[148:151], v49, s[28:31], s55 offen sc1
  s_add_u32 s55, s55, 2048
  s_waitcnt vmcnt(15)
  v_mfma_f32_32x32x16_bf16 v[64:79], v[152:155], a[24:27], v[64:79]
  v_mfma_f32_32x32x16_bf16 v[80:95], v[152:155], a[28:31], v[80:95]
  buffer_load_dwordx4 v[152:155], v48, s[28:31], s55 offen sc1
  s_waitcnt vmcnt(15)
  v_mfma_f32_32x32x16_bf16 v[96:111], v[156:159], a[24:27], v[96:111]
  v_mfma_f32_32x32x16_bf16 v[112:127], v[156:159], a[28:31], v[112:127]
  buffer_load_dwordx4 v[156:159], v49, s[28:31], s55 offen sc1
  s_add_u32 s55, s55, 2048
  s_waitcnt vmcnt(15)
  v_mfma_f32_32x32x16_bf16 v[64:79], v[160:163], a[32:35], v[64:79]
  v_mfma_f32_32x32x16_bf16 v[80:95], v[160:163], a[36:39], v[80:95]
  buffer_load_dwordx4 v[160:163], v48, s[28:31], s55 offen sc1
  s_waitcnt vmcnt(15)
  v_mfma_f32_32x32x16_bf16 v[96:111], v[164:167], a[32:35], v[96:111]
  v_mfma_f32_32x32x16_bf16 v[112:127], v[164:167], a[36:39], v[112:127]
  buffer_load_dwordx4 v[164:167], v49, s[28:31], s55 offen sc1
  s_add_u32 s55, s55, 2048
  s_waitcnt vmcnt(15)
  v_mfma_f32_32x32x16_bf16 v[64:79], v[168:171], a[40:43], v[64:79]
  v_mfma_f32_32x32x16_bf16 v[80:95], v[168:171], a[44:47], v[80:95]
  buffer_load_dwordx4 v[168:171], v48, s[28:31], s55 offen sc1
  s_waitcnt vmcnt(15)
  v_mfma_f32_32x32x16_bf16 v[96:111], v[172:175], a[40:43], v[96:111]
  v_mfma_f32_32x32x16_bf16 v[112:127], v[172:175], a[44:47], v[112:127]
  buffer_load_dwordx4 v[172:175], v49, s[28:31], s55 offen sc1
  s_add_u32 s55, s55, 2048
  s_waitcnt vmcnt(15)
  v_mfma_f32_32x32x16_bf16 v[64:79], v[176:179], a[48:51], v[64:79]
  v_mfma_f32_32x32x16_bf16 v[80:95], v[176:179], a[52:55], v[80:95]
  buffer_load_dwordx4 v[176:179], v48, s[28:31], s55 offen sc1
  s_waitcnt vmcnt(15)
  v_mfma_f32_32x32x16_bf16 v[96:111], v[180:183], a[48:51], v[96:111]
  v_mfma_f32_32x32x16_bf16 v[112:127], v[180:183], a[52:55], v[112:127]
  buffer_load_dwordx4 v[180:183], v49, s[28:31], s55 offen sc1
  s_add_u32 s55, s55, 2048
  s_waitcnt vmcnt(15)
  v_mfma_f32_32x32x16_bf16 v[64:79], v[184:187], a[56:59], v[64:79]
  v_mfma_f32_32x32x16_bf16 v[80:95], v[184:187], a[60:63], v[80:95]
  buffer_load_dwordx4 v[184:187], v48, s[28:31], s55 offen sc1
  s_waitcnt vmcnt(15)
  v_mfma_f32_32x32x16_bf16 v[96:111], v[188:191], a[56:59], v[96:111]
  v_mfma_f32_32x32x16_bf16 v[112:127], v[188:191], a[60:63], v[112:127]
  buffer_load_dwordx4 v[188:191], v49, s[28:31], s55 offen sc1
  s_add_u32 s55, s55, 2048
  s_waitcnt vmcnt(15)
  v_mfma_f32_32x32x16_bf16 v[64:79], v[128:131], a[64:67], v[64:79]
  v_mfma_f32_32x32x16_bf16 v[80:95], v[128:131], a[68:71], v[80:95]
  buffer_load_dwordx4 v[128:131], v48, s[28:31], s55 offen sc1
  s_waitcnt vmcnt(15)
  v_mfma_f32_32x32x16_bf16 v[96:111], v[132:135], a[64:67], v[96:111]
  v_mfma_f32_32x32x16_bf16 v[112:127], v[132:135], a[68:71], v[112:127]
  buffer_load_dwordx4 v[132:135], v49, s[28:31], s55 offen sc1
  s_add_u32 s55, s55, 2048
  s_waitcnt vmcnt(15)
  v_mfma_f32_32x32x16_bf16 v[64:79], v[136:139], a[72:75], v[64:79]
  v_mfma_f32_32x32x16_bf16 v[80:95], v[136:139], a[76:79], v[80:95]
  buffer_load_dwordx4 v[136:139], v48, s[28:31], s55 offen sc1
  s_waitcnt vmcnt(15)
  v_mfma_f32_32x32x16_bf16 v[96:111], v[140:143], a[72:75], v[96:111]
  v_mfma_f32_32x32x16_bf16 v[112:127], v[140:143], a[76:79], v[112:127]
  buffer_load_dwordx4 v[140:143], v49, s[28:31], s55 offen sc1
  s_add_u32 s55, s55, 2048
  s_waitcnt vmcnt(15)
  v_mfma_f32_32x32x16_bf16 v[64:79], v[144:147], a[80:83], v[64:79]
  v_mfma_f32_32x32x16_bf16 v[80:95], v[144:147], a[84:87], v[80:95]
  buffer_load_dwordx4 v[144:147], v48, s[28:31], s55 offen sc1
  s_waitcnt vmcnt(15)
  v_mfma_f32_32x32x16_bf16 v[96:111], v[148:151], a[80:83], v[96:111]
  v_mfma_f32_32x32x16_bf16 v[112:127], v[148:151], a[84:87], v[112:127]
  buffer_load_dwordx4 v[148:151], v49, s[28:31], s55 offen sc1
  s_add_u32 s55, s55, 2048
  ds_read_b64_tr_b16 a[112:113], v30 offset:0
  ds_read_b64_tr_b16 a[114:115], v30 offset:1024
  ds_read_b64_tr_b16 a[116:117], v31 offset:0
  ds_read_b64_tr_b16 a[118:119], v31 offset:1024
  s_waitcnt vmcnt(15)
  v_mfma_f32_32x32x16_bf16 v[64:79], v[152:155], a[88:91], v[64:79]
  v_mfma_f32_32x32x16_bf16 v[80:95], v[152:155], a[92:95], v[80:95]
  buffer_load_dwordx4 v[152:155], v48, s[28:31], s55 offen sc1
  s_waitcnt vmcnt(15)
  v_mfma_f32_32x32x16_bf16 v[96:111], v[156:159], a[88:91], v[96:111]
  v_mfma_f32_32x32x16_bf16 v[112:127], v[156:159], a[92:95], v[112:127]
  buffer_load_dwordx4 v[156:159], v49, s[28:31], s55 offen sc1
  s_add_u32 s55, s55, 2048
  ds_read_b64_tr_b16 a[120:121], v30 offset:2048
  ds_read_b64_tr_b16 a[122:123], v30 offset:3072
  ds_read_b64_tr_b16 a[124:125], v31 offset:2048
  ds_read_b64_tr_b16 a[126:127], v31 offset:3072
  s_waitcnt vmcnt(15)
  v_mfma_f32_32x32x16_bf16 v[64:79], v[160:163], a[96:99], v[64:79]
  v_mfma_f32_32x32x16_bf16 v[80:95], v[160:163], a[100:103], v[80:95]
  buffer_load_dwordx4 v[160:163], v48, s[28:31], s55 offen sc1
  s_waitcnt vmcnt(15)
  v_mfma_f32_32x32x16_bf16 v[96:111], v[164:167], a[96:99], v[96:111]
  v_mfma_f32_32x32x16_bf16 v[112:127], v[164:167], a[100:103], v[112:127]
  buffer_load_dwordx4 v[164:167], v49, s[28:31], s55 offen sc1
  s_add_u32 s55, s55, 2048
  ds_read_b64_tr_b16 a[128:129], v30 offset:4096
  ds_read_b64_tr_b16 a[130:131], v30 offset:5120
  ds_read_b64_tr_b16 a[132:133], v31 offset:4096
  ds_read_b64_tr_b16 a[134:135], v31 offset:5120
  s_waitcnt vmcnt(15)
  v_mfma_f32_32x32x16_bf16 v[64:79], v[168:171], a[104:107], v[64:79]
  v_mfma_f32_32x32x16_bf16 v[80:95], v[168:171], a[108:111], v[80:95]
  buffer_load_dwordx4 v[168:171], v48, s[28:31], s55 offen sc1
  s_waitcnt vmcnt(15)
  v_mfma_f32_32x32x16_bf16 v[96:111], v[172:175], a[104:107], v[96:111]
  v_mfma_f32_32x32x16_bf16 v[112:127], v[172:175], a[108:111], v[112:127]
  buffer_load_dwordx4 v[172:175], v49, s[28:31], s55 offen sc1
  s_add_u32 s55, s55, 2048
  v_mov_b32 v33, 4
  s_mov_b32 s72, 12591104
  s_mov_b32 exec_lo, 0xff
  s_mov_b32 exec_hi, 0
  buffer_load_dword v34, v32, s[28:31], s72 offen sc1
  s_mov_b64 exec, -1
  ds_read_b64_tr_b16 a[136:137], v30 offset:6144
  ds_read_b64_tr_b16 a[138:139], v30 offset:7168
  ds_read_b64_tr_b16 a[140:141], v31 offset:6144
  ds_read_b64_tr_b16 a[142:143], v31 offset:7168
  s_waitcnt vmcnt(16) lgkmcnt(14)
  v_mfma_f32_32x32x16_bf16 v[64:79], v[176:179], a[112:115], v[64:79]
  s_waitcnt lgkmcnt(12)
  v_mfma_f32_32x32x16_bf16 v[80:95], v[176:179], a[116:119], v[80:95]
  buffer_load_dwordx4 v[176:179], v48, s[28:31], s55 offen sc1
  s_waitcnt vmcnt(16)
  v_mfma_f32_32x32x16_bf16 v[96:111], v[180:183], a[112:115], v[96:111]
  v_mfma_f32_32x32x16_bf16 v[112:127], v[180:183], a[116:119], v[112:127]
  buffer_load_dwordx4 v[180:183], v49, s[28:31], s55 offen sc1
  s_add_u32 s55, s55, 2048
  ds_read_b64_tr_b16 a[144:145], v30 offset:8192
  ds_read_b64_tr_b16 a[146:147], v30 offset:9216
  ds_read_b64_tr_b16 a[148:149], v31 offset:8192
  ds_read_b64_tr_b16 a[150:151], v31 offset:9216
  s_waitcnt vmcnt(16) lgkmcnt(14)
  v_mfma_f32_32x32x16_bf16 v[64:79], v[184:187], a[120:123], v[64:79]
  s_waitcnt lgkmcnt(12)
  v_mfma_f32_32x32x16_bf16 v[80:95], v[184:187], a[124:127], v[80:95]
  buffer_load_dwordx4 v[184:187], v48, s[28:31], s55 offen sc1
  s_waitcnt vmcnt(16)
  v_mfma_f32_32x32x16_bf16 v[96:111], v[188:191], a[120:123], v[96:111]
  v_mfma_f32_32x32x16_bf16 v[112:127], v[188:191], a[124:127], v[112:127]
  buffer_load_dwordx4 v[188:191], v49, s[28:31], s55 offen sc1
  s_add_u32 s55, s55, 2048
  ds_read_b64_tr_b16 a[152:153], v30 offset:10240
  ds_read_b64_tr_b16 a[154:155], v30 offset:11264
  ds_read_b64_tr_b16 a[156:157], v31 offset:10240
  ds_read_b64_tr_b16 a[158:159], v31 offset:11264
  s_waitcnt vmcnt(16) lgkmcnt(14)
  v_mfma_f32_32x32x16_bf16 v[64:79], v[128:131], a[128:131], v[64:79]
  s_waitcnt lgkmcnt(12)
  v_mfma_f32_32x32x16_bf16 v[80:95], v[128:131], a[132:135], v[80:95]
  buffer_load_dwordx4 v[128:131], v48, s[28:31], s55 offen sc1
  s_waitcnt vmcnt(16)
  v_mfma_f32_32x32x16_bf16 v[96:111], v[132:135], a[128:131], v[96:111]
  v_mfma_f32_32x32x16_bf16 v[112:127], v[132:135], a[132:135], v[112:127]
  buffer_load_dwordx4 v[132:135], v49, s[28:31], s55 offen sc1
  s_add_u32 s55, s55, 2048
  ds_read_b64_tr_b16 a[160:161], v30 offset:12288
  ds_read_b64_tr_b16 a[162:163], v30 offset:13312
  ds_read_b64_tr_b16 a[164:165], v31 offset:12288
  ds_read_b64_tr_b16 a[166:167], v31 offset:13312
  s_waitcnt vmcnt(16) lgkmcnt(14)
  v_mfma_f32_32x32x16_bf16 v[64:79], v[136:139], a[136:139], v[64:79]
  s_waitcnt lgkmcnt(12)
  v_mfma_f32_32x32x16_bf16 v[80:95], v[136:139], a[140:143], v[80:95]
  buffer_load_dwordx4 v[136:139], v48, s[28:31], s55 offen sc1
  s_waitcnt vmcnt(16)
  v_mfma_f32_32x32x16_bf16 v[96:111], v[140:143], a[136:139], v[96:111]
  v_mfma_f32_32x32x16_bf16 v[112:127], v[140:143], a[140:143], v[112:127]
  buffer_load_dwordx4 v[140:143], v49, s[28:31], s55 offen sc1
  s_add_u32 s55, s55, 2048
  ds_read_b64_tr_b16 a[168:169], v30 offset:14336
  ds_read_b64_tr_b16 a[170:171], v30 offset:15360
  ds_read_b64_tr_b16 a[172:173], v31 offset:14336
  ds_read_b64_tr_b16 a[174:175], v31 offset:15360
  s_waitcnt vmcnt(16) lgkmcnt(14)
  v_mfma_f32_32x32x16_bf16 v[64:79], v[144:147], a[144:147], v[64:79]
  s_waitcnt lgkmcnt(12)
  v_mfma_f32_32x32x16_bf16 v[80:95], v[144:147], a[148:151], v[80:95]
  buffer_load_dwordx4 v[144:147], v48, s[28:31], s55 offen sc1
  s_waitcnt vmcnt(16)
  v_mfma_f32_32x32x16_bf16 v[96:111], v[148:151], a[144:147], v[96:111]
  v_mfma_f32_32x32x16_bf16 v[112:127], v[148:151], a[148:151], v[112:127]
  buffer_load_dwordx4 v[148:151], v49, s[28:31], s55 offen sc1
  s_add_u32 s55, s55, 2048
  ds_read_b64_tr_b16 a[176:177], v30 offset:16384
  ds_read_b64_tr_b16 a[178:179], v30 offset:17408
  ds_read_b64_tr_b16 a[180:181], v31 offset:16384
  ds_read_b64_tr_b16 a[182:183], v31 offset:17408
  s_waitcnt vmcnt(16) lgkmcnt(14)
  v_mfma_f32_32x32x16_bf16 v[64:79], v[152:155], a[152:155], v[64:79]
  s_waitcnt lgkmcnt(12)
  v_mfma_f32_32x32x16_bf16 v[80:95], v[152:155], a[156:159], v[80:95]
  buffer_load_dwordx4 v[152:155], v48, s[28:31], s55 offen sc1
  s_waitcnt vmcnt(16)
  v_mfma_f32_32x32x16_bf16 v[96:111], v[156:159], a[152:155], v[96:111]
  v_mfma_f32_32x32x16_bf16 v[112:127], v[156:159], a[156:159], v[112:127]
  buffer_load_dwordx4 v[156:159], v49, s[28:31], s55 offen sc1
  s_add_u32 s55, s55, 2048
  s_mov_b32 s73, 0
  s_waitcnt vmcnt(12)
  v_mov_b32 v35, v34
  s_mov_b32 exec_lo, 0xff
  s_mov_b32 exec_hi, 0
fzf_zc_l:
  v_cmp_ge_u32 vcc, v35, v33
  s_nop 2
  s_cmp_eq_u64 vcc, exec
  s_cbranch_scc1 fzf_zc_d
  buffer_load_dword v35, v32, s[28:31], s72 offen sc1
  s_add_u32 s73, s73, 1
  s_waitcnt vmcnt(0)
  s_cmp_lt_u32 s73, 131072
  s_cbranch_scc1 fzf_zc_l
fzf_zc_d:
  s_mov_b64 exec, -1
  ds_read_b64_tr_b16 a[184:185], v30 offset:18432
  ds_read_b64_tr_b16 a[186:187], v30 offset:19456
  ds_read_b64_tr_b16 a[188:189], v31 offset:18432
  ds_read_b64_tr_b16 a[190:191], v31 offset:19456
  s_waitcnt lgkmcnt(14)
  v_mfma_f32_32x32x16_bf16 v[64:79], v[160:163], a[160:163], v[64:79]
  s_waitcnt lgkmcnt(12)
  v_mfma_f32_32x32x16_bf16 v[80:95], v[160:163], a[164:167], v[80:95]
  v_mfma_f32_32x32x16_bf16 v[96:111], v[164:167], a[160:163], v[96:111]
  v_mfma_f32_32x32x16_bf16 v[112:127], v[164:167], a[164:167], v[112:127]
  s_add_u32 m0, s98, 0
  s_nop 0
  buffer_load_dwordx4 v28, s[28:31], s51 offen sc1 lds
  buffer_load_dwordx4 v29, s[28:31], s51 offen offset:1024 sc1 lds
  s_add_u32 s51, s51, 65536
  buffer_load_dwordx4 v[192:195], v48, s[28:31], s97 offen sc1
  buffer_load_dwordx4 v[196:199], v49, s[28:31], s97 offen sc1
  s_add_u32 s97, s97, 2048
  buffer_load_dwordx4 v[200:203], v48, s[28:31], s97 offen sc1
  ds_read_b64_tr_b16 a[192:193], v30 offset:20480
  ds_read_b64_tr_b16 a[194:195], v30 offset:21504
  ds_read_b64_tr_b16 a[196:197], v31 offset:20480
  ds_read_b64_tr_b16 a[198:199], v31 offset:21504
  s_waitcnt lgkmcnt(14)
  v_mfma_f32_32x32x16_bf16 v[64:79], v[168:171], a[168:171], v[64:79]
  s_waitcnt lgkmcnt(12)
  v_mfma_f32_32x32x16_bf16 v[80:95], v[168:171], a[172:175], v[80:95]
  v_mfma_f32_32x32x16_bf16 v[96:111], v[172:175], a[168:171], v[96:111]
  v_mfma_f32_32x32x16_bf16 v[112:127], v[172:175], a[172:175], v[112:127]
  s_add_u32 m0, s98, 2048
  s_nop 0
  buffer_load_dwordx4 v28, s[28:31], s51 offen sc1 lds
  buffer_load_dwordx4 v29, s[28:31], s51 offen offset:1024 sc1 lds
  s_add_u32 s51, s51, 65536
  buffer_load_dwordx4 v[204:207], v49, s[28:31], s97 offen sc1
  s_add_u32 s97, s97, 2048
  buffer_load_dwordx4 v[208:211], v48, s[28:31], s97 offen sc1
  buffer_load_dwordx4 v[212:215], v49, s[28:31], s97 offen sc1
  ds_read_b64_tr_b16 a[200:201], v30 offset:22528
  ds_read_b64_tr_b16 a[202:203], v30 offset:23552
  ds_read_b64_tr_b16 a[204:205], v31 offset:22528
  ds_read_b64_tr_b16 a[206:207], v31 offset:23552
  s_waitcnt vmcnt(21) lgkmcnt(14)
  v_mfma_f32_32x32x16_bf16 v[64:79], v[176:179], a[176:179], v[64:79]
  s_waitcnt lgkmcnt(12)
  v_mfma_f32_32x32x16_bf16 v[80:95], v[176:179], a[180:183], v[80:95]
  s_waitcnt vmcnt(20)
  v_mfma_f32_32x32x16_bf16 v[96:111], v[180:183], a[176:179], v[96:111]
  v_mfma_f32_32x32x16_bf16 v[112:127], v[180:183], a[180:183], v[112:127]
  s_add_u32 m0, s98, 4096
  s_nop 0
  buffer_load_dwordx4 v28, s[28:31], s51 offen sc1 lds
  buffer_load_dwordx4 v29, s[28:31], s51 offen offset:1024 sc1 lds
  s_add_u32 s51, s51, 65536
  s_add_u32 s97, s97, 2048
  buffer_load_dwordx4 v[216:219], v48, s[28:31], s97 offen sc1
  buffer_load_dwordx4 v[220:223], v49, s[28:31], s97 offen sc1
  s_add_u32 s97, s97, 2048
  ds_read_b64_tr_b16 a[208:209], v30 offset:24576
  ds_read_b64_tr_b16 a[210:211], v30 offset:25600
  ds_read_b64_tr_b16 a[212:213], v31 offset:24576
  ds_read_b64_tr_b16 a[214:215], v31 offset:25600
  s_waitcnt vmcnt(23) lgkmcnt(14)
  v_mfma_f32_32x32x16_bf16 v[64:79], v[184:187], a[184:187], v[64:79]
  s_waitcnt lgkmcnt(12)
  v_mfma_f32_32x32x16_bf16 v[80:95], v[184:187], a[188:191], v[80:95]
  s_waitcnt vmcnt(22)
  v_mfma_f32_32x32x16_bf16 v[96:111], v[188:191], a[184:187], v[96:111]
  v_mfma_f32_32x32x16_bf16 v[112:127], v[188:191], a[188:191], v[112:127]
  s_add_u32 m0, s98, 6144
  s_nop 0
  buffer_load_dwordx4 v28, s[28:31], s51 offen sc1 lds
  buffer_load_dwordx4 v29, s[28:31], s51 offen offset:1024 sc1 lds
  s_add_u32 s51, s51, 65536
  buffer_load_dwordx4 v[224:227], v48, s[28:31], s97 offen sc1
  buffer_load_dwordx4 v[228:231], v49, s[28:31], s97 offen sc1
  s_add_u32 s97, s97, 2048
  buffer_load_dwordx4 v[232:235], v48, s[28:31], s97 offen sc1
  ds_read_b64_tr_b16 a[216:217], v30 offset:26624
  ds_read_b64_tr_b16 a[218:219], v30 offset:27648
  ds_read_b64_tr_b16 a[220:221], v31 offset:26624
  ds_read_b64_tr_b16 a[222:223], v31 offset:27648
  s_waitcnt vmcnt(26) lgkmcnt(14)
  v_mfma_f32_32x32x16_bf16 v[64:79], v[128:131], a[192:195], v[64:79]
  s_waitcnt lgkmcnt(12)
  v_mfma_f32_32x32x16_bf16 v[80:95], v[128:131], a[196:199], v[80:95]
  s_waitcnt vmcnt(25)
  v_mfma_f32_32x32x16_bf16 v[96:111], v[132:135], a[192:195], v[96:111]
  v_mfma_f32_32x32x16_bf16 v[112:127], v[132:135], a[196:199], v[112:127]
  s_add_u32 m0, s98, 8192
  s_nop 0
  buffer_load_dwordx4 v28, s[28:31], s51 offen sc1 lds
  buffer_load_dwordx4 v29, s[28:31], s51 offen offset:1024 sc1 lds
  s_add_u32 s51, s51, 65536
  buffer_load_dwordx4 v[236:239], v49, s[28:31], s97 offen sc1
  s_add_u32 s97, s97, 2048
  buffer_load_dwordx4 v[240:243], v48, s[28:31], s97 offen sc1
  buffer_load_dwordx4 v[244:247], v49, s[28:31], s97 offen sc1
  s_waitcnt vmcnt(22)
  ds_read_b64_tr_b16 a[224:225], v30 offset:0
  ds_read_b64_tr_b16 a[226:227], v30 offset:1024
  ds_read_b64_tr_b16 a[228:229], v31 offset:0
  ds_read_b64_tr_b16 a[230:231], v31 offset:1024
  s_waitcnt lgkmcnt(14)
  v_mfma_f32_32x32x16_bf16 v[64:79], v[136:139], a[200:203], v[64:79]
  s_waitcnt lgkmcnt(12)
  v_mfma_f32_32x32x16_bf16 v[80:95], v[136:139], a[204:207], v[80:95]
  v_mfma_f32_32x32x16_bf16 v[96:111], v[140:143], a[200:203], v[96:111]
  v_mfma_f32_32x32x16_bf16 v[112:127], v[140:143], a[204:207], v[112:127]
  s_add_u32 m0, s98, 10240
  s_nop 0
  buffer_load_dwordx4 v28, s[28:31], s51 offen sc1 lds
  buffer_load_dwordx4 v29, s[28:31], s51 offen offset:1024 sc1 lds
  s_add_u32 s51, s51, 65536
  s_add_u32 s97, s97, 2048
  buffer_load_dwordx4 v[248:251], v48, s[28:31], s97 offen sc1
  buffer_load_dwordx4 v[252:255], v49, s[28:31], s97 offen sc1
  s_add_u32 s97, s97, 2048
  s_waitcnt vmcnt(21)
  ds_read_b64_tr_b16 a[232:233], v30 offset:2048
  ds_read_b64_tr_b16 a[234:235], v30 offset:3072
  ds_read_b64_tr_b16 a[236:237], v31 offset:2048
  ds_read_b64_tr_b16 a[238:239], v31 offset:3072
  s_waitcnt lgkmcnt(14)
  v_mfma_f32_32x32x16_bf16 v[64:79], v[144:147], a[208:211], v[64:79]
  s_waitcnt lgkmcnt(12)
  v_mfma_f32_32x32x16_bf16 v[80:95], v[144:147], a[212:215], v[80:95]
  v_mfma_f32_32x32x16_bf16 v[96:111], v[148:151], a[208:211], v[96:111]
  v_mfma_f32_32x32x16_bf16 v[112:127], v[148:151], a[212:215], v[112:127]
  s_add_u32 m0, s98, 12288
  s_nop 0
  buffer_load_dwordx4 v28, s[28:31], s51 offen sc1 lds
  buffer_load_dwordx4 v29, s[28:31], s51 offen offset:1024 sc1 lds
  s_add_u32 s51, s51, 65536
  buffer_load_dwordx4 v[50:53], v60, s[40:43], s59 offen
  buffer_load_dwordx4 v[54:57], v60, s[40:43], s59 offen offset:16
  s_mov_b32 s32, s18
  s_and_b32 s33, s19, 0xffff
  s_waitcnt vmcnt(20)
  ds_read_b64_tr_b16 a[240:241], v30 offset:4096
  ds_read_b64_tr_b16 a[242:243], v30 offset:5120
  ds_read_b64_tr_b16 a[244:245], v31 offset:4096
  ds_read_b64_tr_b16 a[246:247], v31 offset:5120
  s_waitcnt lgkmcnt(14)
  v_mfma_f32_32x32x16_bf16 v[64:79], v[152:155], a[216:219], v[64:79]
  s_waitcnt lgkmcnt(12)
  v_mfma_f32_32x32x16_bf16 v[80:95], v[152:155], a[220:223], v[80:95]
  v_mfma_f32_32x32x16_bf16 v[96:111], v[156:159], a[216:219], v[96:111]
  v_mfma_f32_32x32x16_bf16 v[112:127], v[156:159], a[220:223], v[112:127]
  s_add_u32 m0, s98, 14336
  s_nop 0
  buffer_load_dwordx4 v28, s[28:31], s51 offen sc1 lds
  buffer_load_dwordx4 v29, s[28:31], s51 offen offset:1024 sc1 lds
  s_add_u32 s51, s51, 65536
  s_mov_b32 s34, 4096
  s_mov_b32 s35, 0x20000
  buffer_load_ushort v58, v61, s[32:35], s58 offen
  s_waitcnt vmcnt(19)
  ds_read_b64_tr_b16 a[248:249], v30 offset:6144
  ds_read_b64_tr_b16 a[250:251], v30 offset:7168
  ds_read_b64_tr_b16 a[252:253], v31 offset:6144
  ds_read_b64_tr_b16 a[254:255], v31 offset:7168
  s_waitcnt lgkmcnt(14)
  v_mfma_f32_32x32x16_bf16 v[64:79], v[192:195], a[224:227], v[64:79]
  s_waitcnt lgkmcnt(12)
  v_mfma_f32_32x32x16_bf16 v[80:95], v[192:195], a[228:231], v[80:95]
  v_mfma_f32_32x32x16_bf16 v[96:111], v[196:199], a[224:227], v[96:111]
  v_mfma_f32_32x32x16_bf16 v[112:127], v[196:199], a[228:231], v[112:127]
  s_waitcnt vmcnt(14)
  ds_read_b64_tr_b16 a[224:225], v30 offset:8192
  ds_read_b64_tr_b16 a[226:227], v30 offset:9216
  ds_read_b64_tr_b16 a[228:229], v31 offset:8192
  ds_read_b64_tr_b16 a[230:231], v31 offset:9216
  s_waitcnt lgkmcnt(14)
  v_mfma_f32_32x32x16_bf16 v[64:79], v[200:203], a[232:235], v[64:79]
  s_waitcnt lgkmcnt(12)
  v_mfma_f32_32x32x16_bf16 v[80:95], v[200:203], a[236:239], v[80:95]
  v_mfma_f32_32x32x16_bf16 v[96:111], v[204:207], a[232:235], v[96:111]
  v_mfma_f32_32x32x16_bf16 v[112:127], v[204:207], a[236:239], v[112:127]
  s_waitcnt vmcnt(9)
  ds_read_b64_tr_b16 a[232:233], v30 offset:10240
  ds_read_b64_tr_b16 a[234:235], v30 offset:11264
  ds_read_b64_tr_b16 a[236:237], v31 offset:10240
  ds_read_b64_tr_b16 a[238:239], v31 offset:11264
  s_waitcnt lgkmcnt(14)
  v_mfma_f32_32x32x16_bf16 v[64:79], v[208:211], a[240:243], v[64:79]
  s_waitcnt lgkmcnt(12)
  v_mfma_f32_32x32x16_bf16 v[80:95], v[208:211], a[244:247], v[80:95]
  v_mfma_f32_32x32x16_bf16 v[96:111], v[212:215], a[240:243], v[96:111]
  v_mfma_f32_32x32x16_bf16 v[112:127], v[212:215], a[244:247], v[112:127]
  s_waitcnt vmcnt(5)
  ds_read_b64_tr_b16 a[240:241], v30 offset:12288
  ds_read_b64_tr_b16 a[242:243], v30 offset:13312
  ds_read_b64_tr_b16 a[244:245], v31 offset:12288
  ds_read_b64_tr_b16 a[246:247], v31 offset:13312
  s_waitcnt lgkmcnt(14)
  v_mfma_f32_32x32x16_bf16 v[64:79], v[216:219], a[248:251], v[64:79]
  s_waitcnt lgkmcnt(12)
  v_mfma_f32_32x32x16_bf16 v[80:95], v[216:219], a[252:255], v[80:95]
  v_mfma_f32_32x32x16_bf16 v[96:111], v[220:223], a[248:251], v[96:111]
  v_mfma_f32_32x32x16_bf16 v[112:127], v[220:223], a[252:255], v[112:127]
  s_waitcnt vmcnt(1)
  ds_read_b64_tr_b16 a[248:249], v30 offset:14336
  ds_read_b64_tr_b16 a[250:251], v30 offset:15360
  ds_read_b64_tr_b16 a[252:253], v31 offset:14336
  ds_read_b64_tr_b16 a[254:255], v31 offset:15360
  s_waitcnt lgkmcnt(14)
  v_mfma_f32_32x32x16_bf16 v[64:79], v[224:227], a[224:227], v[64:79]
  s_waitcnt lgkmcnt(12)
  v_mfma_f32_32x32x16_bf16 v[80:95], v[224:227], a[228:231], v[80:95]
  v_mfma_f32_32x32x16_bf16 v[96:111], v[228:231], a[224:227], v[96:111]
  v_mfma_f32_32x32x16_bf16 v[112:127], v[228:231], a[228:231], v[112:127]
  s_waitcnt lgkmcnt(10)
  v_mfma_f32_32x32x16_bf16 v[64:79], v[232:235], a[232:235], v[64:79]
  s_waitcnt lgkmcnt(8)
  v_mfma_f32_32x32x16_bf16 v[80:95], v[232:235], a[236:239], v[80:95]
  v_mfma_f32_32x32x16_bf16 v[96:111], v[236:239], a[232:235], v[96:111]
  v_mfma_f32_32x32x16_bf16 v[112:127], v[236:239], a[236:239], v[112:127]
  s_waitcnt lgkmcnt(6)
  v_mfma_f32_32x32x16_bf16 v[64:79], v[240:243], a[240:243], v[64:79]
  s_waitcnt lgkmcnt(4)
  v_mfma_f32_32x32x16_bf16 v[80:95], v[240:243], a[244:247], v[80:95]
  v_mfma_f32_32x32x16_bf16 v[96:111], v[244:247], a[240:243], v[96:111]
  v_mfma_f32_32x32x16_bf16 v[112:127], v[244:247], a[244:247], v[112:127]
  s_waitcnt lgkmcnt(2)
  v_mfma_f32_32x32x16_bf16 v[64:79], v[248:251], a[248:251], v[64:79]
  s_waitcnt lgkmcnt(0)
  v_mfma_f32_32x32x16_bf16 v[80:95], v[248:251], a[252:255], v[80:95]
  v_mfma_f32_32x32x16_bf16 v[96:111], v[252:255], a[248:251], v[96:111]
  v_mfma_f32_32x32x16_bf16 v[112:127], v[252:255], a[252:255], v[112:127]
  s_mov_b32 s40, s22
  s_and_b32 s41, s23, 0xffff
  s_mov_b32 s42, 2097152
  s_mov_b32 s43, 0x20000
  s_barrier
  s_nop 4
  ds_write_b128 v9, v[80:83] offset:0
  ds_write_b128 v9, v[84:87] offset:1024
  ds_write_b128 v9, v[88:91] offset:2048
  ds_write_b128 v9, v[92:95] offset:3072
  ds_write_b128 v10, v[96:99] offset:0
  ds_write_b128 v10, v[100:103] offset:1024
  ds_write_b128 v10, v[104:107] offset:2048
  ds_write_b128 v10, v[108:111] offset:3072
  ds_write_b128 v11, v[112:115] offset:0
  ds_write_b128 v11, v[116:119] offset:1024
  ds_write_b128 v11, v[120:123] offset:2048
  ds_write_b128 v11, v[124:127] offset:3072
  v_lshlrev_b32 v32, 16, v50
  v_and_b32 v33, 0xffff0000, v50
  v_lshlrev_b32 v34, 16, v51
  v_and_b32 v35, 0xffff0000, v51
  v_lshlrev_b32 v36, 16, v52
  v_and_b32 v37, 0xffff0000, v52
  v_lshlrev_b32 v38, 16, v53
  v_and_b32 v39, 0xffff0000, v53
  v_lshlrev_b32 v40, 16, v54
  v_and_b32 v41, 0xffff0000, v54
  v_lshlrev_b32 v42, 16, v55
  v_and_b32 v43, 0xffff0000, v55
  v_lshlrev_b32 v44, 16, v56
  v_and_b32 v45, 0xffff0000, v56
  v_lshlrev_b32 v46, 16, v57
  v_and_b32 v47, 0xffff0000, v57
  s_waitcnt vmcnt(0)
  v_lshlrev_b32 v59, 16, v58
  v_lshlrev_b32 v58, 16, v58
  v_pk_add_f32 v[64:65], v[64:65], v[32:33]
  v_pk_add_f32 v[66:67], v[66:67], v[34:35]
  v_pk_add_f32 v[68:69], v[68:69], v[36:37]
  v_pk_add_f32 v[70:71], v[70:71], v[38:39]
  v_pk_add_f32 v[72:73], v[72:73], v[40:41]
  v_pk_add_f32 v[74:75], v[74:75], v[42:43]
  v_pk_add_f32 v[76:77], v[76:77], v[44:45]
  v_pk_add_f32 v[78:79], v[78:79], v[46:47]
  v_pk_add_f32 v[64:65], v[64:65], v[58:59]
  v_pk_add_f32 v[66:67], v[66:67], v[58:59]
  v_pk_add_f32 v[68:69], v[68:69], v[58:59]
  v_pk_add_f32 v[70:71], v[70:71], v[58:59]
  v_pk_add_f32 v[72:73], v[72:73], v[58:59]
  v_pk_add_f32 v[74:75], v[74:75], v[58:59]
  v_pk_add_f32 v[76:77], v[76:77], v[58:59]
  v_pk_add_f32 v[78:79], v[78:79], v[58:59]
  s_waitcnt lgkmcnt(0)
  s_barrier
  ds_read_b128 v[128:131], v12 offset:0
  ds_read_b128 v[132:135], v12 offset:1024
  ds_read_b128 v[136:139], v12 offset:2048
  ds_read_b128 v[140:143], v12 offset:3072
  ds_read_b128 v[144:147], v12 offset:4096
  ds_read_b128 v[148:151], v12 offset:5120
  ds_read_b128 v[152:155], v12 offset:6144
  ds_read_b128 v[156:159], v12 offset:7168
  ds_read_b128 v[160:163], v12 offset:8192
  ds_read_b128 v[164:167], v12 offset:9216
  ds_read_b128 v[168:171], v12 offset:10240
  ds_read_b128 v[172:175], v12 offset:11264
  s_waitcnt lgkmcnt(8)
  v_pk_add_f32 v[64:65], v[64:65], v[128:129]
  v_pk_add_f32 v[66:67], v[66:67], v[130:131]
  v_pk_add_f32 v[68:69], v[68:69], v[132:133]
  v_pk_add_f32 v[70:71], v[70:71], v[134:135]
  v_pk_add_f32 v[72:73], v[72:73], v[136:137]
  v_pk_add_f32 v[74:75], v[74:75], v[138:139]
  v_pk_add_f32 v[76:77], v[76:77], v[140:141]
  v_pk_add_f32 v[78:79], v[78:79], v[142:143]
  s_waitcnt lgkmcnt(4)
  v_pk_add_f32 v[64:65], v[64:65], v[144:145]
  v_pk_add_f32 v[66:67], v[66:67], v[146:147]
  v_pk_add_f32 v[68:69], v[68:69], v[148:149]
  v_pk_add_f32 v[70:71], v[70:71], v[150:151]
  v_pk_add_f32 v[72:73], v[72:73], v[152:153]
  v_pk_add_f32 v[74:75], v[74:75], v[154:155]
  v_pk_add_f32 v[76:77], v[76:77], v[156:157]
  v_pk_add_f32 v[78:79], v[78:79], v[158:159]
  s_waitcnt lgkmcnt(0)
  v_pk_add_f32 v[64:65], v[64:65], v[160:161]
  v_pk_add_f32 v[66:67], v[66:67], v[162:163]
  v_pk_add_f32 v[68:69], v[68:69], v[164:165]
  v_pk_add_f32 v[70:71], v[70:71], v[166:167]
  v_pk_add_f32 v[72:73], v[72:73], v[168:169]
  v_pk_add_f32 v[74:75], v[74:75], v[170:171]
  v_pk_add_f32 v[76:77], v[76:77], v[172:173]
  v_pk_add_f32 v[78:79], v[78:79], v[174:175]
  v_cvt_pk_bf16_f32 v16, v64, v65
  v_cvt_pk_bf16_f32 v17, v66, v67
  v_cvt_pk_bf16_f32 v18, v68, v69
  v_cvt_pk_bf16_f32 v19, v70, v71
  v_cvt_pk_bf16_f32 v20, v72, v73
  v_cvt_pk_bf16_f32 v21, v74, v75
  v_cvt_pk_bf16_f32 v22, v76, v77
  v_cvt_pk_bf16_f32 v23, v78, v79
  buffer_store_dwordx4 v[16:19], v60, s[40:43], s59 offen
  buffer_store_dwordx4 v[20:23], v60, s[40:43], s59 offen offset:16
fz_end:
fz_done:
  s_endpgm
fz_codeend:
.section .rodata,"a"
.p2align 6
.amdhsa_kernel parallel_sum__spectral_gfnet__mixer_token_mlp__prompt_kernel
  .amdhsa_next_free_vgpr 512
  .amdhsa_next_free_sgpr 102
  .amdhsa_accum_offset 256
  .amdhsa_group_segment_fixed_size 0
  .amdhsa_kernarg_size 88
  .amdhsa_user_sgpr_count 2
  .amdhsa_user_sgpr_kernarg_segment_ptr 1
  .amdhsa_system_sgpr_workgroup_id_x 1
  .amdhsa_float_denorm_mode_32 3
.end_amdhsa_kernel
```
